```python
import torch

def _softmax(x, axis=-1):
    return torch.softmax(x, dim=axis)
def _gelu(x):
    return torch.nn.functional.gelu(x, approximate="tanh")
def _silu(x):
    return torch.nn.functional.silu(x)
def _sigmoid(x):
    return torch.sigmoid(x)
def _layernorm(x, axis=-1, eps=1e-5):
    m = x.mean(dim=axis, keepdim=True)
    v = x.var(dim=axis, keepdim=True, unbiased=False)
    return (x - m) / torch.sqrt(v + eps)
def _scatter_add(tgt, idx, src, axis=0):
    return tgt.clone().index_add_(axis, idx, src)
def _segment_sum(src, seg, n):
    out = torch.zeros((n,) + src.shape[1:], dtype=src.dtype)
    return out.index_add_(0, seg, src)
def _pad(x, pw):
    flat = tuple(v for pair in reversed(pw) for v in pair)
    return torch.nn.functional.pad(x, flat)

kernel_name = 'recurrent_scan__grouped_kv_mqa__moe_arch_mod__prompt'

def setup_inputs():

    _w = (lambda a: (lambda t: t.to(torch.bfloat16) if t.is_floating_point() else t)(torch.as_tensor(a)))
    def _A_setup():
        B, S, D, H = 1, 2048, 640, 32
        Dh = D // H
        return {
            "x": _w((lambda *s: torch.randn(*s, dtype=torch.bfloat16) * 0.05)(B, S, D)),
            "wq": _w((lambda *s: torch.randn(*s, dtype=torch.bfloat16) * 0.05)(D, H * Dh)),
            "wk": _w((lambda *s: torch.randn(*s, dtype=torch.bfloat16) * 0.05)(D, Dh)),
            "wv": _w((lambda *s: torch.randn(*s, dtype=torch.bfloat16) * 0.05)(D, Dh)),
            "wo": _w((lambda *s: torch.randn(*s, dtype=torch.bfloat16) * 0.05)(H * Dh, D)),
        }
    _A_in = _A_setup()

    def _B_setup():
        B, S, D, F, C = 1, 2048, 640, 1728, 1
        return {
            "x": _w((lambda *s: torch.randn(*s, dtype=torch.bfloat16) * 0.05)(B, S, D)),
            "w_r": _w((lambda *s: torch.randn(*s, dtype=torch.bfloat16) * 1.6)(D)),
            "w_gate": _w((lambda *s: torch.randn(*s, dtype=torch.bfloat16) * 0.1)(D, F)),
            "w_up": _w((lambda *s: torch.randn(*s, dtype=torch.bfloat16) * 0.1)(D, F)),
            "w_down": _w((lambda *s: torch.randn(*s, dtype=torch.bfloat16) * 0.1)(F, D)),
        }
    _B_in = _B_setup()

    return {
        "A_x": _A_in["x"],
        "A_wq": _A_in["wq"],
        "A_wk": _A_in["wk"],
        "A_wv": _A_in["wv"],
        "A_wo": _A_in["wo"],
        "B_x": _B_in["x"],
        "B_w_r": _B_in["w_r"],
        "B_w_gate": _B_in["w_gate"],
        "B_w_up": _B_in["w_up"],
        "B_w_down": _B_in["w_down"],
    }

def reference(A_x, A_wq, A_wk, A_wv, A_wo, B_x, B_w_r, B_w_gate, B_w_up, B_w_down):
    def _A_ref(x, wq, wk, wv, wo):
        B, S, D = x.shape
        H = 32
        Dh = D // H
        q = (lambda x, *d: x.permute(*d))((x @ wq).reshape(B, S, H, Dh), 0, 2, 1, 3)
        k = x @ wk
        v = x @ wv
        scores = torch.einsum("bhqd,bkd->bhqk", q, k) * (Dh ** -0.5)
        p = _softmax(scores, axis=-1)
        o = torch.einsum("bhqk,bkd->bhqd", p, v)
        return (lambda x, *d: x.permute(*d))(o, 0, 2, 1, 3).reshape(B, S, H * Dh) @ wo

    def _B_ref(x, w_r, w_gate, w_up, w_down):
        B, S, D = x.shape
        C = 1
        r = x @ w_r
        idx = torch.argsort(-r, axis=-1)[:, :C]
        idx_e = (lambda x, n, axis: torch.repeat_interleave(x, n, dim=axis))(idx.reshape(B, C, 1), D, axis=2)
        x_sel = (lambda x, i, axis: torch.take_along_dim(x, i, dim=axis))(x, idx_e, axis=1)
        g = _silu(x_sel @ w_gate)
        u = x_sel @ w_up
        y = (g * u) @ w_down
        r_sel = _sigmoid((lambda x, i, axis: torch.take_along_dim(x, i, dim=axis))(r, idx, axis=1))
        y = y * r_sel.reshape(B, C, 1)
        b_off = (torch.arange(B) * S).reshape(B, 1)
        flat_idx = (idx + b_off).reshape(B * C)
        zero = (x * 0.0).reshape(B * S, D)
        upd = _scatter_add(zero, flat_idx, y.reshape(B * C, D), axis=0)
        return x + upd.reshape(B, S, D)

    x = A_x
    xn = _layernorm(x, axis=-1)
    s = _A_ref(xn, A_wq, A_wk, A_wv, A_wo)
    g = _silu(_B_ref(xn, B_w_r, B_w_gate, B_w_up, B_w_down))
    return x + s * g
```

```asm
; @launch grid=(256,1,1) block=(512,1,1) lds=159360
.amdgcn_target "amdgcn-amd-amdhsa--gfx950"
.text
.globl recurrent_scan__grouped_kv_mqa__moe_arch_mod__prompt_kernel
.p2align 8
.type recurrent_scan__grouped_kv_mqa__moe_arch_mod__prompt_kernel,@function
recurrent_scan__grouped_kv_mqa__moe_arch_mod__prompt_kernel:
  s_cmp_ge_u32 s2, 256
  s_cbranch_scc1 KF_END
  s_load_dwordx16 s[48:63], s[0:1], 0
  s_load_dwordx8 s[64:71], s[0:1], 64
  s_load_dwordx2 s[72:73], s[0:1], 96
  s_getpc_b64 s[74:75]
KF_PC:
  v_lshrrev_b32 v1, 6, v0
  v_lshlrev_b32 v5, 7, v0
  v_min_u32 v5, CODE_END-KF_PC-4, v5
  global_load_dword v6, v5, s[74:75]
  v_and_b32 v2, 63, v0
  v_readfirstlane_b32 s3, v1
  s_and_b32 s36, s2, 7
  s_lshr_b32 s37, s2, 3
  s_and_b32 s33, s37, 7
  s_lshr_b32 s38, s37, 3
  s_lshl_b32 s32, s36, 2
  s_add_u32 s32, s32, s38
  s_mul_i32 s35, s33, 160
  v_lshrrev_b32 v3, 4, v2
  v_and_b32 v4, 15, v2
  s_mov_b32 s6, 2621440
  s_mov_b32 s7, 0x20000
  s_mov_b32 s10, 6553600
  s_mov_b32 s11, 0x20000
  s_mov_b32 s15, 0x20000
  s_mov_b32 s18, 819200
  s_mov_b32 s19, 0x20000
  s_mov_b32 s23, 0x20000
  s_and_b32 s34, s3, 3
  s_cmp_ge_u32 s3, 4
  s_cbranch_scc1 KF_HELP
  v_mul_u32_u24 v7, 1280, v4
  v_lshl_add_u32 v8, v3, 3, v7
  v_lshl_add_u32 v7, v3, 4, v7
  s_mul_i32 s40, s32, 81920
  s_mul_i32 s41, s34, 20480
  s_add_u32 s40, s40, s41
  s_add_u32 s41, s40, s35
  s_mov_b32 s14, 2621440
  s_waitcnt lgkmcnt(0)
  s_mov_b64 s[4:5], s[48:49]
  s_mov_b64 s[8:9], s[72:73]
  s_mov_b64 s[12:13], s[68:69]
  buffer_load_dwordx4 v[172:175], v7, s[4:7], s40 offen offset:0
  buffer_load_dwordx4 v[176:179], v7, s[4:7], s40 offen offset:64
  buffer_load_dwordx4 v[180:183], v7, s[4:7], s40 offen offset:128
  buffer_load_dwordx4 v[184:187], v7, s[4:7], s40 offen offset:192
  buffer_load_dwordx4 v[188:191], v7, s[4:7], s40 offen offset:256
  buffer_load_dwordx4 v[192:195], v7, s[4:7], s40 offen offset:320
  buffer_load_dwordx4 v[196:199], v7, s[4:7], s40 offen offset:384
  buffer_load_dwordx4 v[200:203], v7, s[4:7], s40 offen offset:448
  buffer_load_dwordx4 v[204:207], v7, s[4:7], s40 offen offset:512
  buffer_load_dwordx4 v[208:211], v7, s[4:7], s40 offen offset:576
  buffer_load_dwordx4 v[212:215], v7, s[4:7], s40 offen offset:640
  buffer_load_dwordx4 v[216:219], v7, s[4:7], s40 offen offset:704
  buffer_load_dwordx4 v[220:223], v7, s[4:7], s40 offen offset:768
  buffer_load_dwordx4 v[224:227], v7, s[4:7], s40 offen offset:832
  buffer_load_dwordx4 v[228:231], v7, s[4:7], s40 offen offset:896
  buffer_load_dwordx4 v[232:235], v7, s[4:7], s40 offen offset:960
  buffer_load_dwordx4 v[236:239], v7, s[4:7], s40 offen offset:1024
  buffer_load_dwordx4 v[240:243], v7, s[4:7], s40 offen offset:1088
  buffer_load_dwordx4 v[244:247], v7, s[4:7], s40 offen offset:1152
  buffer_load_dwordx4 v[248:251], v7, s[4:7], s40 offen offset:1216
  buffer_load_dwordx2 v[152:153], v8, s[4:7], s41 offen offset:0
  buffer_load_dwordx2 v[154:155], v8, s[4:7], s41 offen offset:32
  buffer_load_dwordx2 v[156:157], v8, s[4:7], s41 offen offset:64
  buffer_load_dwordx2 v[158:159], v8, s[4:7], s41 offen offset:96
  buffer_load_dwordx2 v[160:161], v8, s[4:7], s41 offen offset:128
  v_bfe_u32 v74, v2, 2, 2
  v_and_b32 v75, 3, v2
  v_lshl_add_u32 v76, v3, 3, v74
  v_mul_u32_u24 v76, 40, v76
  v_add_u32 v76, 102400, v76
  v_lshl_add_u32 v9, v75, 3, v76
  v_add_u32 v76, 32, v76
  v_lshl_add_u32 v74, v3, 2, v74
  v_lshlrev_b32 v74, 3, v74
  v_add_u32 v74, 145408, v74
  v_cmp_eq_u32 vcc, 0, v75
  s_nop 1
  v_cndmask_b32 v10, v74, v76, vcc
  v_mov_b32 v74, 320
  v_mov_b32 v76, 1280
  v_cndmask_b32 v11, v74, v76, vcc
  v_lshrrev_b32 v74, 2, v2
  v_mul_u32_u24 v74, 160, v74
  v_and_b32 v75, 1, v2
  v_bfe_u32 v76, v2, 1, 1
  v_mad_u32_u24 v12, v75, 40, v74
  v_lshl_add_u32 v12, v76, 4, v12
  v_and_b32 v75, 3, v2
  v_mad_u32_u24 v13, v75, 40, v74
  v_add_u32 v13, 32, v13
  v_mov_b32 v64, 0
  v_mov_b32 v65, 0
  v_mov_b32 v66, 0
  v_mov_b32 v67, 0
  v_mov_b32 v144, 0x3f803f80
  v_mov_b32 v145, 0x3f803f80
  v_mov_b32 v146, 0x3f803f80
  v_mov_b32 v147, 0x3f803f80
  s_lshl_b32 s42, s34, 2
  s_add_u32 s42, s42, 151824
  v_mov_b32 v14, s42
  v_mov_b32 v15, 151808
  s_barrier
  ds_read_b64_tr_b16 v[16:17], v9 offset:0
  ds_read_b64_tr_b16 v[18:19], v9 offset:160
  ds_read_b64_tr_b16 v[20:21], v10
  ds_read_b64_tr_b16 v[22:23], v10 offset:160
  v_add_u32 v10, v11, v10
  ds_read_b64_tr_b16 v[24:25], v9 offset:1280
  ds_read_b64_tr_b16 v[26:27], v9 offset:1440
  ds_read_b64_tr_b16 v[28:29], v10
  ds_read_b64_tr_b16 v[30:31], v10 offset:160
  v_add_u32 v10, v11, v10
  ds_read_b64_tr_b16 v[32:33], v9 offset:2560
  ds_read_b64_tr_b16 v[34:35], v9 offset:2720
  ds_read_b64_tr_b16 v[36:37], v10
  ds_read_b64_tr_b16 v[38:39], v10 offset:160
  v_add_u32 v10, v11, v10
  s_waitcnt lgkmcnt(8)
  v_mfma_f32_16x16x32_bf16 v[140:143], v[20:23], v[144:147], 0
  v_mfma_f32_16x16x32_bf16 v[136:139], v[16:19], v[144:147], 0
  s_waitcnt vmcnt(24)
  v_mfma_f32_16x16x32_bf16 v[60:63], v[20:23], v[172:175], 0
  v_mfma_f32_16x16x32_bf16 v[56:59], v[16:19], v[172:175], 0
  ds_read_b64_tr_b16 v[40:41], v9 offset:3840
  ds_read_b64_tr_b16 v[42:43], v9 offset:4000
  ds_read_b64_tr_b16 v[44:45], v10
  ds_read_b64_tr_b16 v[46:47], v10 offset:160
  v_add_u32 v10, v11, v10
  v_dot2_f32_bf16 v64, v172, v172, v64
  v_dot2_f32_bf16 v65, v173, v173, v65
  v_dot2_f32_bf16 v66, v174, v174, v66
  v_dot2_f32_bf16 v67, v175, v175, v67
  s_waitcnt lgkmcnt(8)
  v_mfma_f32_16x16x32_bf16 v[140:143], v[28:31], v[144:147], v[140:143]
  v_mfma_f32_16x16x32_bf16 v[136:139], v[24:27], v[144:147], v[136:139]
  s_waitcnt vmcnt(23)
  v_mfma_f32_16x16x32_bf16 v[60:63], v[28:31], v[176:179], v[60:63]
  v_mfma_f32_16x16x32_bf16 v[56:59], v[24:27], v[176:179], v[56:59]
  ds_read_b64_tr_b16 v[16:17], v9 offset:5120
  ds_read_b64_tr_b16 v[18:19], v9 offset:5280
  ds_read_b64_tr_b16 v[20:21], v10
  ds_read_b64_tr_b16 v[22:23], v10 offset:160
  v_add_u32 v10, v11, v10
  v_dot2_f32_bf16 v64, v176, v176, v64
  v_dot2_f32_bf16 v65, v177, v177, v65
  v_dot2_f32_bf16 v66, v178, v178, v66
  v_dot2_f32_bf16 v67, v179, v179, v67
  s_waitcnt lgkmcnt(8)
  v_mfma_f32_16x16x32_bf16 v[140:143], v[36:39], v[144:147], v[140:143]
  v_mfma_f32_16x16x32_bf16 v[136:139], v[32:35], v[144:147], v[136:139]
  s_waitcnt vmcnt(22)
  v_mfma_f32_16x16x32_bf16 v[60:63], v[36:39], v[180:183], v[60:63]
  v_mfma_f32_16x16x32_bf16 v[56:59], v[32:35], v[180:183], v[56:59]
  ds_read_b64_tr_b16 v[24:25], v9 offset:6400
  ds_read_b64_tr_b16 v[26:27], v9 offset:6560
  ds_read_b64_tr_b16 v[28:29], v10
  ds_read_b64_tr_b16 v[30:31], v10 offset:160
  v_add_u32 v10, v11, v10
  v_dot2_f32_bf16 v64, v180, v180, v64
  v_dot2_f32_bf16 v65, v181, v181, v65
  v_dot2_f32_bf16 v66, v182, v182, v66
  v_dot2_f32_bf16 v67, v183, v183, v67
  s_waitcnt lgkmcnt(8)
  v_mfma_f32_16x16x32_bf16 v[140:143], v[44:47], v[144:147], v[140:143]
  v_mfma_f32_16x16x32_bf16 v[136:139], v[40:43], v[144:147], v[136:139]
  s_waitcnt vmcnt(21)
  v_mfma_f32_16x16x32_bf16 v[60:63], v[44:47], v[184:187], v[60:63]
  v_mfma_f32_16x16x32_bf16 v[56:59], v[40:43], v[184:187], v[56:59]
  ds_read_b64_tr_b16 v[32:33], v9 offset:7680
  ds_read_b64_tr_b16 v[34:35], v9 offset:7840
  ds_read_b64_tr_b16 v[36:37], v10
  ds_read_b64_tr_b16 v[38:39], v10 offset:160
  v_add_u32 v10, v11, v10
  v_dot2_f32_bf16 v64, v184, v184, v64
  v_dot2_f32_bf16 v65, v185, v185, v65
  v_dot2_f32_bf16 v66, v186, v186, v66
  v_dot2_f32_bf16 v67, v187, v187, v67
  s_waitcnt lgkmcnt(8)
  v_mfma_f32_16x16x32_bf16 v[140:143], v[20:23], v[144:147], v[140:143]
  v_mfma_f32_16x16x32_bf16 v[136:139], v[16:19], v[144:147], v[136:139]
  s_waitcnt vmcnt(20)
  v_mfma_f32_16x16x32_bf16 v[60:63], v[20:23], v[188:191], v[60:63]
  v_mfma_f32_16x16x32_bf16 v[56:59], v[16:19], v[188:191], v[56:59]
  ds_read_b64_tr_b16 v[40:41], v9 offset:8960
  ds_read_b64_tr_b16 v[42:43], v9 offset:9120
  ds_read_b64_tr_b16 v[44:45], v10
  ds_read_b64_tr_b16 v[46:47], v10 offset:160
  v_add_u32 v10, v11, v10
  v_dot2_f32_bf16 v64, v188, v188, v64
  v_dot2_f32_bf16 v65, v189, v189, v65
  v_dot2_f32_bf16 v66, v190, v190, v66
  v_dot2_f32_bf16 v67, v191, v191, v67
  s_waitcnt lgkmcnt(8)
  v_mfma_f32_16x16x32_bf16 v[140:143], v[28:31], v[144:147], v[140:143]
  v_mfma_f32_16x16x32_bf16 v[136:139], v[24:27], v[144:147], v[136:139]
  s_waitcnt vmcnt(19)
  v_mfma_f32_16x16x32_bf16 v[60:63], v[28:31], v[192:195], v[60:63]
  v_mfma_f32_16x16x32_bf16 v[56:59], v[24:27], v[192:195], v[56:59]
  ds_read_b64_tr_b16 v[16:17], v9 offset:10240
  ds_read_b64_tr_b16 v[18:19], v9 offset:10400
  ds_read_b64_tr_b16 v[20:21], v10
  ds_read_b64_tr_b16 v[22:23], v10 offset:160
  v_add_u32 v10, v11, v10
  v_dot2_f32_bf16 v64, v192, v192, v64
  v_dot2_f32_bf16 v65, v193, v193, v65
  v_dot2_f32_bf16 v66, v194, v194, v66
  v_dot2_f32_bf16 v67, v195, v195, v67
  s_waitcnt lgkmcnt(8)
  v_mfma_f32_16x16x32_bf16 v[140:143], v[36:39], v[144:147], v[140:143]
  v_mfma_f32_16x16x32_bf16 v[136:139], v[32:35], v[144:147], v[136:139]
  s_waitcnt vmcnt(18)
  v_mfma_f32_16x16x32_bf16 v[60:63], v[36:39], v[196:199], v[60:63]
  v_mfma_f32_16x16x32_bf16 v[56:59], v[32:35], v[196:199], v[56:59]
  ds_read_b64_tr_b16 v[24:25], v9 offset:11520
  ds_read_b64_tr_b16 v[26:27], v9 offset:11680
  ds_read_b64_tr_b16 v[28:29], v10
  ds_read_b64_tr_b16 v[30:31], v10 offset:160
  v_add_u32 v10, v11, v10
  v_dot2_f32_bf16 v64, v196, v196, v64
  v_dot2_f32_bf16 v65, v197, v197, v65
  v_dot2_f32_bf16 v66, v198, v198, v66
  v_dot2_f32_bf16 v67, v199, v199, v67
  s_waitcnt lgkmcnt(8)
  v_mfma_f32_16x16x32_bf16 v[140:143], v[44:47], v[144:147], v[140:143]
  v_mfma_f32_16x16x32_bf16 v[136:139], v[40:43], v[144:147], v[136:139]
  s_waitcnt vmcnt(17)
  v_mfma_f32_16x16x32_bf16 v[60:63], v[44:47], v[200:203], v[60:63]
  v_mfma_f32_16x16x32_bf16 v[56:59], v[40:43], v[200:203], v[56:59]
  ds_read_b64_tr_b16 v[32:33], v9 offset:12800
  ds_read_b64_tr_b16 v[34:35], v9 offset:12960
  ds_read_b64_tr_b16 v[36:37], v10
  ds_read_b64_tr_b16 v[38:39], v10 offset:160
  v_add_u32 v10, v11, v10
  v_dot2_f32_bf16 v64, v200, v200, v64
  v_dot2_f32_bf16 v65, v201, v201, v65
  v_dot2_f32_bf16 v66, v202, v202, v66
  v_dot2_f32_bf16 v67, v203, v203, v67
  s_waitcnt lgkmcnt(8)
  v_mfma_f32_16x16x32_bf16 v[140:143], v[20:23], v[144:147], v[140:143]
  v_mfma_f32_16x16x32_bf16 v[136:139], v[16:19], v[144:147], v[136:139]
  s_waitcnt vmcnt(16)
  v_mfma_f32_16x16x32_bf16 v[60:63], v[20:23], v[204:207], v[60:63]
  v_mfma_f32_16x16x32_bf16 v[56:59], v[16:19], v[204:207], v[56:59]
  ds_read_b64_tr_b16 v[40:41], v9 offset:14080
  ds_read_b64_tr_b16 v[42:43], v9 offset:14240
  ds_read_b64_tr_b16 v[44:45], v10
  ds_read_b64_tr_b16 v[46:47], v10 offset:160
  v_add_u32 v10, v11, v10
  v_dot2_f32_bf16 v64, v204, v204, v64
  v_dot2_f32_bf16 v65, v205, v205, v65
  v_dot2_f32_bf16 v66, v206, v206, v66
  v_dot2_f32_bf16 v67, v207, v207, v67
  s_waitcnt lgkmcnt(8)
  v_mfma_f32_16x16x32_bf16 v[140:143], v[28:31], v[144:147], v[140:143]
  v_mfma_f32_16x16x32_bf16 v[136:139], v[24:27], v[144:147], v[136:139]
  s_waitcnt vmcnt(15)
  v_mfma_f32_16x16x32_bf16 v[60:63], v[28:31], v[208:211], v[60:63]
  v_mfma_f32_16x16x32_bf16 v[56:59], v[24:27], v[208:211], v[56:59]
  ds_read_b64_tr_b16 v[16:17], v9 offset:15360
  ds_read_b64_tr_b16 v[18:19], v9 offset:15520
  ds_read_b64_tr_b16 v[20:21], v10
  ds_read_b64_tr_b16 v[22:23], v10 offset:160
  v_add_u32 v10, v11, v10
  v_dot2_f32_bf16 v64, v208, v208, v64
  v_dot2_f32_bf16 v65, v209, v209, v65
  v_dot2_f32_bf16 v66, v210, v210, v66
  v_dot2_f32_bf16 v67, v211, v211, v67
  s_waitcnt lgkmcnt(8)
  v_mfma_f32_16x16x32_bf16 v[140:143], v[36:39], v[144:147], v[140:143]
  v_mfma_f32_16x16x32_bf16 v[136:139], v[32:35], v[144:147], v[136:139]
  s_waitcnt vmcnt(14)
  v_mfma_f32_16x16x32_bf16 v[60:63], v[36:39], v[212:215], v[60:63]
  v_mfma_f32_16x16x32_bf16 v[56:59], v[32:35], v[212:215], v[56:59]
  ds_read_b64_tr_b16 v[24:25], v9 offset:16640
  ds_read_b64_tr_b16 v[26:27], v9 offset:16800
  ds_read_b64_tr_b16 v[28:29], v10
  ds_read_b64_tr_b16 v[30:31], v10 offset:160
  v_add_u32 v10, v11, v10
  v_dot2_f32_bf16 v64, v212, v212, v64
  v_dot2_f32_bf16 v65, v213, v213, v65
  v_dot2_f32_bf16 v66, v214, v214, v66
  v_dot2_f32_bf16 v67, v215, v215, v67
  s_waitcnt lgkmcnt(8)
  v_mfma_f32_16x16x32_bf16 v[140:143], v[44:47], v[144:147], v[140:143]
  v_mfma_f32_16x16x32_bf16 v[136:139], v[40:43], v[144:147], v[136:139]
  s_waitcnt vmcnt(13)
  v_mfma_f32_16x16x32_bf16 v[60:63], v[44:47], v[216:219], v[60:63]
  v_mfma_f32_16x16x32_bf16 v[56:59], v[40:43], v[216:219], v[56:59]
  ds_read_b64_tr_b16 v[32:33], v9 offset:17920
  ds_read_b64_tr_b16 v[34:35], v9 offset:18080
  ds_read_b64_tr_b16 v[36:37], v10
  ds_read_b64_tr_b16 v[38:39], v10 offset:160
  v_add_u32 v10, v11, v10
  v_dot2_f32_bf16 v64, v216, v216, v64
  v_dot2_f32_bf16 v65, v217, v217, v65
  v_dot2_f32_bf16 v66, v218, v218, v66
  v_dot2_f32_bf16 v67, v219, v219, v67
  s_waitcnt lgkmcnt(8)
  v_mfma_f32_16x16x32_bf16 v[140:143], v[20:23], v[144:147], v[140:143]
  v_mfma_f32_16x16x32_bf16 v[136:139], v[16:19], v[144:147], v[136:139]
  s_waitcnt vmcnt(12)
  v_mfma_f32_16x16x32_bf16 v[60:63], v[20:23], v[220:223], v[60:63]
  v_mfma_f32_16x16x32_bf16 v[56:59], v[16:19], v[220:223], v[56:59]
  ds_read_b64_tr_b16 v[40:41], v9 offset:19200
  ds_read_b64_tr_b16 v[42:43], v9 offset:19360
  ds_read_b64_tr_b16 v[44:45], v10
  ds_read_b64_tr_b16 v[46:47], v10 offset:160
  v_add_u32 v10, v11, v10
  v_dot2_f32_bf16 v64, v220, v220, v64
  v_dot2_f32_bf16 v65, v221, v221, v65
  v_dot2_f32_bf16 v66, v222, v222, v66
  v_dot2_f32_bf16 v67, v223, v223, v67
  s_waitcnt lgkmcnt(8)
  v_mfma_f32_16x16x32_bf16 v[140:143], v[28:31], v[144:147], v[140:143]
  v_mfma_f32_16x16x32_bf16 v[136:139], v[24:27], v[144:147], v[136:139]
  s_waitcnt vmcnt(11)
  v_mfma_f32_16x16x32_bf16 v[60:63], v[28:31], v[224:227], v[60:63]
  v_mfma_f32_16x16x32_bf16 v[56:59], v[24:27], v[224:227], v[56:59]
  ds_read_b64_tr_b16 v[16:17], v9 offset:20480
  ds_read_b64_tr_b16 v[18:19], v9 offset:20640
  ds_read_b64_tr_b16 v[20:21], v10
  ds_read_b64_tr_b16 v[22:23], v10 offset:160
  v_add_u32 v10, v11, v10
  v_dot2_f32_bf16 v64, v224, v224, v64
  v_dot2_f32_bf16 v65, v225, v225, v65
  v_dot2_f32_bf16 v66, v226, v226, v66
  v_dot2_f32_bf16 v67, v227, v227, v67
  s_waitcnt lgkmcnt(8)
  v_mfma_f32_16x16x32_bf16 v[140:143], v[36:39], v[144:147], v[140:143]
  v_mfma_f32_16x16x32_bf16 v[136:139], v[32:35], v[144:147], v[136:139]
  s_waitcnt vmcnt(10)
  v_mfma_f32_16x16x32_bf16 v[60:63], v[36:39], v[228:231], v[60:63]
  v_mfma_f32_16x16x32_bf16 v[56:59], v[32:35], v[228:231], v[56:59]
  ds_read_b64_tr_b16 v[24:25], v9 offset:21760
  ds_read_b64_tr_b16 v[26:27], v9 offset:21920
  ds_read_b64_tr_b16 v[28:29], v10
  ds_read_b64_tr_b16 v[30:31], v10 offset:160
  v_add_u32 v10, v11, v10
  v_dot2_f32_bf16 v64, v228, v228, v64
  v_dot2_f32_bf16 v65, v229, v229, v65
  v_dot2_f32_bf16 v66, v230, v230, v66
  v_dot2_f32_bf16 v67, v231, v231, v67
  s_waitcnt lgkmcnt(8)
  v_mfma_f32_16x16x32_bf16 v[140:143], v[44:47], v[144:147], v[140:143]
  v_mfma_f32_16x16x32_bf16 v[136:139], v[40:43], v[144:147], v[136:139]
  s_waitcnt vmcnt(9)
  v_mfma_f32_16x16x32_bf16 v[60:63], v[44:47], v[232:235], v[60:63]
  v_mfma_f32_16x16x32_bf16 v[56:59], v[40:43], v[232:235], v[56:59]
  ds_read_b64_tr_b16 v[32:33], v9 offset:23040
  ds_read_b64_tr_b16 v[34:35], v9 offset:23200
  ds_read_b64_tr_b16 v[36:37], v10
  ds_read_b64_tr_b16 v[38:39], v10 offset:160
  v_add_u32 v10, v11, v10
  v_dot2_f32_bf16 v64, v232, v232, v64
  v_dot2_f32_bf16 v65, v233, v233, v65
  v_dot2_f32_bf16 v66, v234, v234, v66
  v_dot2_f32_bf16 v67, v235, v235, v67
  s_waitcnt lgkmcnt(8)
  v_mfma_f32_16x16x32_bf16 v[140:143], v[20:23], v[144:147], v[140:143]
  v_mfma_f32_16x16x32_bf16 v[136:139], v[16:19], v[144:147], v[136:139]
  s_waitcnt vmcnt(8)
  v_mfma_f32_16x16x32_bf16 v[60:63], v[20:23], v[236:239], v[60:63]
  v_mfma_f32_16x16x32_bf16 v[56:59], v[16:19], v[236:239], v[56:59]
  ds_read_b64_tr_b16 v[40:41], v9 offset:24320
  ds_read_b64_tr_b16 v[42:43], v9 offset:24480
  ds_read_b64_tr_b16 v[44:45], v10
  ds_read_b64_tr_b16 v[46:47], v10 offset:160
  v_add_u32 v10, v11, v10
  v_dot2_f32_bf16 v64, v236, v236, v64
  v_dot2_f32_bf16 v65, v237, v237, v65
  v_dot2_f32_bf16 v66, v238, v238, v66
  v_dot2_f32_bf16 v67, v239, v239, v67
  s_waitcnt lgkmcnt(8)
  v_mfma_f32_16x16x32_bf16 v[140:143], v[28:31], v[144:147], v[140:143]
  v_mfma_f32_16x16x32_bf16 v[136:139], v[24:27], v[144:147], v[136:139]
  s_waitcnt vmcnt(7)
  v_mfma_f32_16x16x32_bf16 v[60:63], v[28:31], v[240:243], v[60:63]
  v_mfma_f32_16x16x32_bf16 v[56:59], v[24:27], v[240:243], v[56:59]
  v_dot2_f32_bf16 v64, v240, v240, v64
  v_dot2_f32_bf16 v65, v241, v241, v65
  v_dot2_f32_bf16 v66, v242, v242, v66
  v_dot2_f32_bf16 v67, v243, v243, v67
  s_waitcnt lgkmcnt(4)
  v_mfma_f32_16x16x32_bf16 v[140:143], v[36:39], v[144:147], v[140:143]
  v_mfma_f32_16x16x32_bf16 v[136:139], v[32:35], v[144:147], v[136:139]
  s_waitcnt vmcnt(6)
  v_mfma_f32_16x16x32_bf16 v[60:63], v[36:39], v[244:247], v[60:63]
  v_mfma_f32_16x16x32_bf16 v[56:59], v[32:35], v[244:247], v[56:59]
  v_dot2_f32_bf16 v64, v244, v244, v64
  v_dot2_f32_bf16 v65, v245, v245, v65
  v_dot2_f32_bf16 v66, v246, v246, v66
  v_dot2_f32_bf16 v67, v247, v247, v67
  s_waitcnt lgkmcnt(0)
  v_mfma_f32_16x16x32_bf16 v[140:143], v[44:47], v[144:147], v[140:143]
  v_mfma_f32_16x16x32_bf16 v[136:139], v[40:43], v[144:147], v[136:139]
  s_waitcnt vmcnt(5)
  v_mfma_f32_16x16x32_bf16 v[60:63], v[44:47], v[248:251], v[60:63]
  v_mfma_f32_16x16x32_bf16 v[56:59], v[40:43], v[248:251], v[56:59]
  v_dot2_f32_bf16 v64, v248, v248, v64
  v_dot2_f32_bf16 v65, v249, v249, v65
  v_dot2_f32_bf16 v66, v250, v250, v66
  v_dot2_f32_bf16 v67, v251, v251, v67
  s_nop 0
  v_add_f32 v64, v64, v65
  s_nop 0
  v_add_f32 v66, v66, v67
  v_add_f32 v64, v64, v66
  v_mov_b32 v65, v64
  v_mov_b32 v74, v61
  v_mov_b32 v68, v61
  v_permlane16_swap_b32 v64, v65
  s_nop 0
  v_permlane16_swap_b32 v74, v68
  v_add_f32 v64, v64, v65
  v_mov_b32 v65, v64
  v_mul_f32 v68, 0x3acccccd, v68
  s_nop 0
  v_permlane32_swap_b32 v64, v65
  v_add_f32 v64, v64, v65
  v_cvt_pk_bf16_f32 v148, v68, v68
  v_lshlrev_b32 v148, 16, v148
  v_mul_f32 v72, 0x3acccccd, v64
  v_fma_f32 v72, -v68, v68, v72
  v_max_f32 v72, 0, v72
  v_cvt_pk_bf16_f32 v72, v72, v72
  v_lshlrev_b32 v72, 16, v72
  v_add_f32 v72, 0x3727c5ac, v72
  v_cvt_pk_bf16_f32 v72, v72, v72
  v_lshlrev_b32 v72, 16, v72
  v_sqrt_f32 v72, v72
  s_nop 0
  v_cvt_pk_bf16_f32 v72, v72, v72
  v_lshlrev_b32 v72, 16, v72
  v_rcp_f32 v149, v72
  s_cmp_ge_u32 s33, 2
  s_cbranch_scc1 KF_NOPROD
  v_fma_f32 v74, -v148, v136, v56
  v_fma_f32 v75, -v148, v137, v57
  v_fma_f32 v76, -v148, v138, v58
  v_fma_f32 v77, -v148, v139, v59
  v_fma_f32 v78, -v148, v140, v60
  v_fma_f32 v79, -v148, v141, v61
  v_fma_f32 v80, -v148, v142, v62
  v_fma_f32 v81, -v148, v143, v63
  v_mul_f32 v74, v74, v149
  v_mul_f32 v75, v75, v149
  v_mul_f32 v76, v76, v149
  v_mul_f32 v77, v77, v149
  v_mul_f32 v78, v78, v149
  v_mul_f32 v79, v79, v149
  v_mul_f32 v80, v80, v149
  v_mul_f32 v81, v81, v149
  v_cvt_pk_bf16_f32 v74, v74, v75
  v_cvt_pk_bf16_f32 v75, v76, v77
  v_cvt_pk_bf16_f32 v76, v78, v79
  v_cvt_pk_bf16_f32 v77, v80, v81
  s_lshr_b32 s42, s34, 1
  s_mul_i32 s42, s42, 2688
  s_add_u32 s42, s42, 128000
  s_and_b32 s43, s34, 1
  s_cmp_eq_u32 s33, 1
  s_cbranch_scc1 KF_PV
  s_lshl_b32 s44, s43, 4
  v_add_u32 v82, s44, v4
  v_lshrrev_b32 v83, 1, v3
  v_and_b32 v78, 1, v3
  v_lshl_add_u32 v83, v83, 5, v82
  v_lshlrev_b32 v83, 4, v83
  v_lshl_add_u32 v83, v78, 3, v83
  v_add_u32 v83, s42, v83
  ds_write_b64 v83, v[74:75]
  v_lshlrev_b32 v82, 3, v82
  v_add_u32 v82, s42, v82
  v_lshlrev_b32 v78, 16, v76
  v_ashrrev_i32 v79, 31, v78
  v_or_b32 v79, 0x80000000, v79
  v_xor_b32 v78, v78, v79
  v_and_b32 v78, 0xffff0000, v78
  s_lshl_b32 s44, s32, 6
  s_lshl_b32 s45, s34, 4
  s_add_u32 s44, s44, s45
  s_sub_u32 s44, 0xffff, s44
  v_sub_u32 v79, s44, v4
  v_or_b32 v78, v78, v79
  s_lshl_b32 s44, s34, 7
  s_add_u32 s44, s44, 133376
  v_lshlrev_b32 v83, 3, v4
  v_add_u32 v83, s44, v83
  v_max_u32_dpp v78, v78, v78 row_ror:8 row_mask:0xf bank_mask:0xf
  s_nop 1
  v_max_u32_dpp v78, v78, v78 row_ror:4 row_mask:0xf bank_mask:0xf
  s_nop 1
  v_max_u32_dpp v78, v78, v78 row_ror:2 row_mask:0xf bank_mask:0xf
  s_nop 1
  v_max_u32_dpp v78, v78, v78 row_ror:1 row_mask:0xf bank_mask:0xf
  s_lshl_b32 s44, s34, 2
  s_add_u32 s44, s44, 133888
  v_mov_b32 v79, s44
  ds_write_b64 v83, v[148:149]
  s_mov_b64 exec, 0xffff
  ds_write_b64 v82, v[76:77] offset:1024
  s_mov_b64 exec, 0x10000
  ds_write_b32 v79, v78
  s_mov_b64 exec, -1
  s_branch KF_NOPROD
KF_PV:
  s_mul_i32 s43, s43, 672
  s_add_u32 s42, s42, s43
  v_and_b32 v82, 3, v4
  v_lshrrev_b32 v83, 3, v4
  v_lshl_add_u32 v82, v83, 2, v82
  v_lshlrev_b32 v82, 1, v82
  v_bfe_u32 v83, v4, 2, 1
  v_mul_u32_u24 v83, 336, v83
  v_add3_u32 v82, v82, v83, s42
  v_lshl_add_u32 v83, v3, 6, v82
  v_mov_b32 v78, 0x3f80
  ds_write_b16 v83, v74 offset:1280
  ds_write_b16_d16_hi v83, v74 offset:1296
  ds_write_b16 v83, v75 offset:1312
  ds_write_b16_d16_hi v83, v75 offset:1328
  s_mov_b64 exec, 0xffff
  ds_write_b16 v82, v76 offset:1536
  ds_write_b16_d16_hi v82, v76 offset:1552
  ds_write_b16 v82, v77 offset:1568
  ds_write_b16_d16_hi v82, v77 offset:1584
  ds_write_b16 v82, v78 offset:1600
  s_mov_b64 exec, -1
KF_NOPROD:
  ds_write_b32 v14, v144
  v_mul_f32 v73, 0x3ea52b5c, v149
KF_LW0:
  ds_read_b128 v[64:67], v15 offset:0
  s_waitcnt lgkmcnt(0)
  v_min3_u32 v64, v64, v65, v66
  s_nop 0
  v_readfirstlane_b32 s42, v64
  s_nop 0
  s_cmp_ge_u32 s42, 2
  s_cbranch_scc0 KF_LW0
  ds_read_b64_tr_b16 v[16:17], v12 offset:0
  ds_read_b64_tr_b16 v[18:19], v12 offset:2560
  ds_read_b64_tr_b16 v[20:21], v12 offset:8
  ds_read_b64_tr_b16 v[22:23], v12 offset:2568
  ds_read_b64_tr_b16 v[24:25], v12 offset:80
  ds_read_b64_tr_b16 v[26:27], v12 offset:2640
  ds_read_b64_tr_b16 v[28:29], v12 offset:88
  ds_read_b64_tr_b16 v[30:31], v12 offset:2648
  ds_read_b64_tr_b16 v[32:33], v13 offset:0
  ds_read_b64_tr_b16 v[34:35], v13 offset:2560
  ds_read_b64_tr_b16 v[112:113], v12 offset:5120
  ds_read_b64_tr_b16 v[114:115], v12 offset:7680
  ds_read_b64_tr_b16 v[116:117], v12 offset:5128
  ds_read_b64_tr_b16 v[118:119], v12 offset:7688
  s_waitcnt lgkmcnt(12)
  v_mfma_f32_16x16x32_bf16 v[36:39], v[16:19], v[172:175], 0
  v_mfma_f32_16x16x32_bf16 v[76:79], v[16:19], v[144:147], 0
  ds_read_b64_tr_b16 v[120:121], v12 offset:5200
  ds_read_b64_tr_b16 v[122:123], v12 offset:7760
  s_waitcnt lgkmcnt(12)
  v_mfma_f32_16x16x32_bf16 v[40:43], v[20:23], v[172:175], 0
  v_mfma_f32_16x16x32_bf16 v[80:83], v[20:23], v[144:147], 0
  ds_read_b64_tr_b16 v[124:125], v12 offset:5208
  ds_read_b64_tr_b16 v[126:127], v12 offset:7768
  s_waitcnt lgkmcnt(12)
  v_mfma_f32_16x16x32_bf16 v[44:47], v[24:27], v[172:175], 0
  v_mfma_f32_16x16x32_bf16 v[84:87], v[24:27], v[144:147], 0
  ds_read_b64_tr_b16 v[128:129], v13 offset:5120
  ds_read_b64_tr_b16 v[130:131], v13 offset:7680
  s_waitcnt lgkmcnt(12)
  v_mfma_f32_16x16x32_bf16 v[48:51], v[28:31], v[172:175], 0
  v_mfma_f32_16x16x32_bf16 v[88:91], v[28:31], v[144:147], 0
  ds_read_b64_tr_b16 v[16:17], v12 offset:10240
  ds_read_b64_tr_b16 v[18:19], v12 offset:12800
  s_waitcnt lgkmcnt(12)
  v_mfma_f32_16x16x32_bf16 v[52:55], v[32:35], v[172:175], 0
  v_mfma_f32_16x16x32_bf16 v[92:95], v[32:35], v[144:147], 0
  ds_read_b64_tr_b16 v[20:21], v12 offset:10248
  ds_read_b64_tr_b16 v[22:23], v12 offset:12808
  s_waitcnt lgkmcnt(12)
  v_mfma_f32_16x16x32_bf16 v[36:39], v[112:115], v[176:179], v[36:39]
  v_mfma_f32_16x16x32_bf16 v[76:79], v[112:115], v[144:147], v[76:79]
  ds_read_b64_tr_b16 v[24:25], v12 offset:10320
  ds_read_b64_tr_b16 v[26:27], v12 offset:12880
  s_waitcnt lgkmcnt(12)
  v_mfma_f32_16x16x32_bf16 v[40:43], v[116:119], v[176:179], v[40:43]
  v_mfma_f32_16x16x32_bf16 v[80:83], v[116:119], v[144:147], v[80:83]
  ds_read_b64_tr_b16 v[28:29], v12 offset:10328
  ds_read_b64_tr_b16 v[30:31], v12 offset:12888
  s_waitcnt lgkmcnt(12)
  v_mfma_f32_16x16x32_bf16 v[44:47], v[120:123], v[176:179], v[44:47]
  v_mfma_f32_16x16x32_bf16 v[84:87], v[120:123], v[144:147], v[84:87]
  ds_read_b64_tr_b16 v[32:33], v13 offset:10240
  ds_read_b64_tr_b16 v[34:35], v13 offset:12800
  s_waitcnt lgkmcnt(12)
  v_mfma_f32_16x16x32_bf16 v[48:51], v[124:127], v[176:179], v[48:51]
  v_mfma_f32_16x16x32_bf16 v[88:91], v[124:127], v[144:147], v[88:91]
  ds_read_b64_tr_b16 v[112:113], v12 offset:15360
  ds_read_b64_tr_b16 v[114:115], v12 offset:17920
  s_waitcnt lgkmcnt(12)
  v_mfma_f32_16x16x32_bf16 v[52:55], v[128:131], v[176:179], v[52:55]
  v_mfma_f32_16x16x32_bf16 v[92:95], v[128:131], v[144:147], v[92:95]
  ds_read_b64_tr_b16 v[116:117], v12 offset:15368
  ds_read_b64_tr_b16 v[118:119], v12 offset:17928
  s_waitcnt lgkmcnt(12)
  v_mfma_f32_16x16x32_bf16 v[36:39], v[16:19], v[180:183], v[36:39]
  v_mfma_f32_16x16x32_bf16 v[76:79], v[16:19], v[144:147], v[76:79]
  ds_read_b64_tr_b16 v[120:121], v12 offset:15440
  ds_read_b64_tr_b16 v[122:123], v12 offset:18000
  s_waitcnt lgkmcnt(12)
  v_mfma_f32_16x16x32_bf16 v[40:43], v[20:23], v[180:183], v[40:43]
  v_mfma_f32_16x16x32_bf16 v[80:83], v[20:23], v[144:147], v[80:83]
  ds_read_b64_tr_b16 v[124:125], v12 offset:15448
  ds_read_b64_tr_b16 v[126:127], v12 offset:18008
  s_waitcnt lgkmcnt(12)
  v_mfma_f32_16x16x32_bf16 v[44:47], v[24:27], v[180:183], v[44:47]
  v_mfma_f32_16x16x32_bf16 v[84:87], v[24:27], v[144:147], v[84:87]
  ds_read_b64_tr_b16 v[128:129], v13 offset:15360
  ds_read_b64_tr_b16 v[130:131], v13 offset:17920
  s_waitcnt lgkmcnt(12)
  v_mfma_f32_16x16x32_bf16 v[48:51], v[28:31], v[180:183], v[48:51]
  v_mfma_f32_16x16x32_bf16 v[88:91], v[28:31], v[144:147], v[88:91]
  ds_read_b64_tr_b16 v[16:17], v12 offset:20480
  ds_read_b64_tr_b16 v[18:19], v12 offset:23040
  s_waitcnt lgkmcnt(12)
  v_mfma_f32_16x16x32_bf16 v[52:55], v[32:35], v[180:183], v[52:55]
  v_mfma_f32_16x16x32_bf16 v[92:95], v[32:35], v[144:147], v[92:95]
  ds_read_b64_tr_b16 v[20:21], v12 offset:20488
  ds_read_b64_tr_b16 v[22:23], v12 offset:23048
  s_waitcnt lgkmcnt(12)
  v_mfma_f32_16x16x32_bf16 v[36:39], v[112:115], v[184:187], v[36:39]
  v_mfma_f32_16x16x32_bf16 v[76:79], v[112:115], v[144:147], v[76:79]
  ds_read_b64_tr_b16 v[24:25], v12 offset:20560
  ds_read_b64_tr_b16 v[26:27], v12 offset:23120
  s_waitcnt lgkmcnt(12)
  v_mfma_f32_16x16x32_bf16 v[40:43], v[116:119], v[184:187], v[40:43]
  v_mfma_f32_16x16x32_bf16 v[80:83], v[116:119], v[144:147], v[80:83]
  ds_read_b64_tr_b16 v[28:29], v12 offset:20568
  ds_read_b64_tr_b16 v[30:31], v12 offset:23128
  s_waitcnt lgkmcnt(12)
  v_mfma_f32_16x16x32_bf16 v[44:47], v[120:123], v[184:187], v[44:47]
  v_mfma_f32_16x16x32_bf16 v[84:87], v[120:123], v[144:147], v[84:87]
  ds_read_b64_tr_b16 v[32:33], v13 offset:20480
  ds_read_b64_tr_b16 v[34:35], v13 offset:23040
  s_waitcnt lgkmcnt(12)
  v_mfma_f32_16x16x32_bf16 v[48:51], v[124:127], v[184:187], v[48:51]
  v_mfma_f32_16x16x32_bf16 v[88:91], v[124:127], v[144:147], v[88:91]
  ds_read_b64_tr_b16 v[112:113], v12 offset:25600
  ds_read_b64_tr_b16 v[114:115], v12 offset:28160
  s_waitcnt lgkmcnt(12)
  v_mfma_f32_16x16x32_bf16 v[52:55], v[128:131], v[184:187], v[52:55]
  v_mfma_f32_16x16x32_bf16 v[92:95], v[128:131], v[144:147], v[92:95]
  ds_read_b64_tr_b16 v[116:117], v12 offset:25608
  ds_read_b64_tr_b16 v[118:119], v12 offset:28168
  s_waitcnt lgkmcnt(12)
  v_mfma_f32_16x16x32_bf16 v[36:39], v[16:19], v[188:191], v[36:39]
  v_mfma_f32_16x16x32_bf16 v[76:79], v[16:19], v[144:147], v[76:79]
  ds_read_b64_tr_b16 v[120:121], v12 offset:25680
  ds_read_b64_tr_b16 v[122:123], v12 offset:28240
  s_waitcnt lgkmcnt(12)
  v_mfma_f32_16x16x32_bf16 v[40:43], v[20:23], v[188:191], v[40:43]
  v_mfma_f32_16x16x32_bf16 v[80:83], v[20:23], v[144:147], v[80:83]
  ds_read_b64_tr_b16 v[124:125], v12 offset:25688
  ds_read_b64_tr_b16 v[126:127], v12 offset:28248
  s_waitcnt lgkmcnt(12)
  v_mfma_f32_16x16x32_bf16 v[44:47], v[24:27], v[188:191], v[44:47]
  v_mfma_f32_16x16x32_bf16 v[84:87], v[24:27], v[144:147], v[84:87]
  ds_read_b64_tr_b16 v[128:129], v13 offset:25600
  ds_read_b64_tr_b16 v[130:131], v13 offset:28160
  s_waitcnt lgkmcnt(12)
  v_mfma_f32_16x16x32_bf16 v[48:51], v[28:31], v[188:191], v[48:51]
  v_mfma_f32_16x16x32_bf16 v[88:91], v[28:31], v[144:147], v[88:91]
KF_LW6:
  ds_read_b128 v[64:67], v15 offset:0
  s_waitcnt lgkmcnt(0)
  v_min3_u32 v64, v64, v65, v66
  s_nop 0
  v_readfirstlane_b32 s42, v64
  s_nop 0
  s_cmp_ge_u32 s42, 4
  s_cbranch_scc0 KF_LW6
  ds_read_b64_tr_b16 v[16:17], v12 offset:30720
  ds_read_b64_tr_b16 v[18:19], v12 offset:33280
  v_mfma_f32_16x16x32_bf16 v[52:55], v[32:35], v[188:191], v[52:55]
  v_mfma_f32_16x16x32_bf16 v[92:95], v[32:35], v[144:147], v[92:95]
  ds_read_b64_tr_b16 v[20:21], v12 offset:30728
  ds_read_b64_tr_b16 v[22:23], v12 offset:33288
  v_mfma_f32_16x16x32_bf16 v[36:39], v[112:115], v[192:195], v[36:39]
  v_mfma_f32_16x16x32_bf16 v[76:79], v[112:115], v[144:147], v[76:79]
  ds_read_b64_tr_b16 v[24:25], v12 offset:30800
  ds_read_b64_tr_b16 v[26:27], v12 offset:33360
  v_mfma_f32_16x16x32_bf16 v[40:43], v[116:119], v[192:195], v[40:43]
  v_mfma_f32_16x16x32_bf16 v[80:83], v[116:119], v[144:147], v[80:83]
  ds_read_b64_tr_b16 v[28:29], v12 offset:30808
  ds_read_b64_tr_b16 v[30:31], v12 offset:33368
  v_mfma_f32_16x16x32_bf16 v[44:47], v[120:123], v[192:195], v[44:47]
  v_mfma_f32_16x16x32_bf16 v[84:87], v[120:123], v[144:147], v[84:87]
  ds_read_b64_tr_b16 v[32:33], v13 offset:30720
  ds_read_b64_tr_b16 v[34:35], v13 offset:33280
  v_mfma_f32_16x16x32_bf16 v[48:51], v[124:127], v[192:195], v[48:51]
  v_mfma_f32_16x16x32_bf16 v[88:91], v[124:127], v[144:147], v[88:91]
  ds_read_b64_tr_b16 v[112:113], v12 offset:35840
  ds_read_b64_tr_b16 v[114:115], v12 offset:38400
  v_mfma_f32_16x16x32_bf16 v[52:55], v[128:131], v[192:195], v[52:55]
  v_mfma_f32_16x16x32_bf16 v[92:95], v[128:131], v[144:147], v[92:95]
  ds_read_b64_tr_b16 v[116:117], v12 offset:35848
  ds_read_b64_tr_b16 v[118:119], v12 offset:38408
  s_waitcnt lgkmcnt(12)
  v_mfma_f32_16x16x32_bf16 v[36:39], v[16:19], v[196:199], v[36:39]
  v_mfma_f32_16x16x32_bf16 v[76:79], v[16:19], v[144:147], v[76:79]
  ds_read_b64_tr_b16 v[120:121], v12 offset:35920
  ds_read_b64_tr_b16 v[122:123], v12 offset:38480
  s_waitcnt lgkmcnt(12)
  v_mfma_f32_16x16x32_bf16 v[40:43], v[20:23], v[196:199], v[40:43]
  v_mfma_f32_16x16x32_bf16 v[80:83], v[20:23], v[144:147], v[80:83]
  ds_read_b64_tr_b16 v[124:125], v12 offset:35928
  ds_read_b64_tr_b16 v[126:127], v12 offset:38488
  s_waitcnt lgkmcnt(12)
  v_mfma_f32_16x16x32_bf16 v[44:47], v[24:27], v[196:199], v[44:47]
  v_mfma_f32_16x16x32_bf16 v[84:87], v[24:27], v[144:147], v[84:87]
  ds_read_b64_tr_b16 v[128:129], v13 offset:35840
  ds_read_b64_tr_b16 v[130:131], v13 offset:38400
  s_waitcnt lgkmcnt(12)
  v_mfma_f32_16x16x32_bf16 v[48:51], v[28:31], v[196:199], v[48:51]
  v_mfma_f32_16x16x32_bf16 v[88:91], v[28:31], v[144:147], v[88:91]
  ds_read_b64_tr_b16 v[16:17], v12 offset:40960
  ds_read_b64_tr_b16 v[18:19], v12 offset:43520
  s_waitcnt lgkmcnt(12)
  v_mfma_f32_16x16x32_bf16 v[52:55], v[32:35], v[196:199], v[52:55]
  v_mfma_f32_16x16x32_bf16 v[92:95], v[32:35], v[144:147], v[92:95]
  ds_read_b64_tr_b16 v[20:21], v12 offset:40968
  ds_read_b64_tr_b16 v[22:23], v12 offset:43528
  s_waitcnt lgkmcnt(12)
  v_mfma_f32_16x16x32_bf16 v[36:39], v[112:115], v[200:203], v[36:39]
  v_mfma_f32_16x16x32_bf16 v[76:79], v[112:115], v[144:147], v[76:79]
  ds_read_b64_tr_b16 v[24:25], v12 offset:41040
  ds_read_b64_tr_b16 v[26:27], v12 offset:43600
  s_waitcnt lgkmcnt(12)
  v_mfma_f32_16x16x32_bf16 v[40:43], v[116:119], v[200:203], v[40:43]
  v_mfma_f32_16x16x32_bf16 v[80:83], v[116:119], v[144:147], v[80:83]
  ds_read_b64_tr_b16 v[28:29], v12 offset:41048
  ds_read_b64_tr_b16 v[30:31], v12 offset:43608
  s_waitcnt lgkmcnt(12)
  v_mfma_f32_16x16x32_bf16 v[44:47], v[120:123], v[200:203], v[44:47]
  v_mfma_f32_16x16x32_bf16 v[84:87], v[120:123], v[144:147], v[84:87]
  ds_read_b64_tr_b16 v[32:33], v13 offset:40960
  ds_read_b64_tr_b16 v[34:35], v13 offset:43520
  s_waitcnt lgkmcnt(12)
  v_mfma_f32_16x16x32_bf16 v[48:51], v[124:127], v[200:203], v[48:51]
  v_mfma_f32_16x16x32_bf16 v[88:91], v[124:127], v[144:147], v[88:91]
  ds_read_b64_tr_b16 v[112:113], v12 offset:46080
  ds_read_b64_tr_b16 v[114:115], v12 offset:48640
  s_waitcnt lgkmcnt(12)
  v_mfma_f32_16x16x32_bf16 v[52:55], v[128:131], v[200:203], v[52:55]
  v_mfma_f32_16x16x32_bf16 v[92:95], v[128:131], v[144:147], v[92:95]
  ds_read_b64_tr_b16 v[116:117], v12 offset:46088
  ds_read_b64_tr_b16 v[118:119], v12 offset:48648
  s_waitcnt lgkmcnt(12)
  v_mfma_f32_16x16x32_bf16 v[36:39], v[16:19], v[204:207], v[36:39]
  v_mfma_f32_16x16x32_bf16 v[76:79], v[16:19], v[144:147], v[76:79]
  ds_read_b64_tr_b16 v[120:121], v12 offset:46160
  ds_read_b64_tr_b16 v[122:123], v12 offset:48720
  s_waitcnt lgkmcnt(12)
  v_mfma_f32_16x16x32_bf16 v[40:43], v[20:23], v[204:207], v[40:43]
  v_mfma_f32_16x16x32_bf16 v[80:83], v[20:23], v[144:147], v[80:83]
  ds_read_b64_tr_b16 v[124:125], v12 offset:46168
  ds_read_b64_tr_b16 v[126:127], v12 offset:48728
  s_waitcnt lgkmcnt(12)
  v_mfma_f32_16x16x32_bf16 v[44:47], v[24:27], v[204:207], v[44:47]
  v_mfma_f32_16x16x32_bf16 v[84:87], v[24:27], v[144:147], v[84:87]
  ds_read_b64_tr_b16 v[128:129], v13 offset:46080
  ds_read_b64_tr_b16 v[130:131], v13 offset:48640
  s_waitcnt lgkmcnt(12)
  v_mfma_f32_16x16x32_bf16 v[48:51], v[28:31], v[204:207], v[48:51]
  v_mfma_f32_16x16x32_bf16 v[88:91], v[28:31], v[144:147], v[88:91]
  v_add_u32 v12, 51200, v12
  ds_read_b64_tr_b16 v[16:17], v12 offset:0
  ds_read_b64_tr_b16 v[18:19], v12 offset:2560
  s_waitcnt lgkmcnt(12)
  v_mfma_f32_16x16x32_bf16 v[52:55], v[32:35], v[204:207], v[52:55]
  v_mfma_f32_16x16x32_bf16 v[92:95], v[32:35], v[144:147], v[92:95]
  ds_read_b64_tr_b16 v[20:21], v12 offset:8
  ds_read_b64_tr_b16 v[22:23], v12 offset:2568
  s_waitcnt lgkmcnt(12)
  v_mfma_f32_16x16x32_bf16 v[36:39], v[112:115], v[208:211], v[36:39]
  v_mfma_f32_16x16x32_bf16 v[76:79], v[112:115], v[144:147], v[76:79]
  ds_read_b64_tr_b16 v[24:25], v12 offset:80
  ds_read_b64_tr_b16 v[26:27], v12 offset:2640
  s_waitcnt lgkmcnt(12)
  v_mfma_f32_16x16x32_bf16 v[40:43], v[116:119], v[208:211], v[40:43]
  v_mfma_f32_16x16x32_bf16 v[80:83], v[116:119], v[144:147], v[80:83]
  ds_read_b64_tr_b16 v[28:29], v12 offset:88
  ds_read_b64_tr_b16 v[30:31], v12 offset:2648
  s_waitcnt lgkmcnt(12)
  v_mfma_f32_16x16x32_bf16 v[44:47], v[120:123], v[208:211], v[44:47]
  v_mfma_f32_16x16x32_bf16 v[84:87], v[120:123], v[144:147], v[84:87]
  v_add_u32 v13, 51200, v13
  ds_read_b64_tr_b16 v[32:33], v13 offset:0
  ds_read_b64_tr_b16 v[34:35], v13 offset:2560
  s_waitcnt lgkmcnt(12)
  v_mfma_f32_16x16x32_bf16 v[48:51], v[124:127], v[208:211], v[48:51]
  v_mfma_f32_16x16x32_bf16 v[88:91], v[124:127], v[144:147], v[88:91]
  ds_read_b64_tr_b16 v[112:113], v12 offset:5120
  ds_read_b64_tr_b16 v[114:115], v12 offset:7680
  s_waitcnt lgkmcnt(12)
  v_mfma_f32_16x16x32_bf16 v[52:55], v[128:131], v[208:211], v[52:55]
  v_mfma_f32_16x16x32_bf16 v[92:95], v[128:131], v[144:147], v[92:95]
  ds_read_b64_tr_b16 v[116:117], v12 offset:5128
  ds_read_b64_tr_b16 v[118:119], v12 offset:7688
  s_waitcnt lgkmcnt(12)
  v_mfma_f32_16x16x32_bf16 v[36:39], v[16:19], v[212:215], v[36:39]
  v_mfma_f32_16x16x32_bf16 v[76:79], v[16:19], v[144:147], v[76:79]
  ds_read_b64_tr_b16 v[120:121], v12 offset:5200
  ds_read_b64_tr_b16 v[122:123], v12 offset:7760
  s_waitcnt lgkmcnt(12)
  v_mfma_f32_16x16x32_bf16 v[40:43], v[20:23], v[212:215], v[40:43]
  v_mfma_f32_16x16x32_bf16 v[80:83], v[20:23], v[144:147], v[80:83]
  ds_read_b64_tr_b16 v[124:125], v12 offset:5208
  ds_read_b64_tr_b16 v[126:127], v12 offset:7768
  s_waitcnt lgkmcnt(12)
  v_mfma_f32_16x16x32_bf16 v[44:47], v[24:27], v[212:215], v[44:47]
  v_mfma_f32_16x16x32_bf16 v[84:87], v[24:27], v[144:147], v[84:87]
  ds_read_b64_tr_b16 v[128:129], v13 offset:5120
  ds_read_b64_tr_b16 v[130:131], v13 offset:7680
  s_waitcnt lgkmcnt(12)
  v_mfma_f32_16x16x32_bf16 v[48:51], v[28:31], v[212:215], v[48:51]
  v_mfma_f32_16x16x32_bf16 v[88:91], v[28:31], v[144:147], v[88:91]
KF_LW12:
  ds_read_b128 v[64:67], v15 offset:0
  s_waitcnt lgkmcnt(0)
  v_min3_u32 v64, v64, v65, v66
  s_nop 0
  v_readfirstlane_b32 s42, v64
  s_nop 0
  s_cmp_ge_u32 s42, 6
  s_cbranch_scc0 KF_LW12
  ds_read_b64_tr_b16 v[16:17], v12 offset:10240
  ds_read_b64_tr_b16 v[18:19], v12 offset:12800
  v_mfma_f32_16x16x32_bf16 v[52:55], v[32:35], v[212:215], v[52:55]
  v_mfma_f32_16x16x32_bf16 v[92:95], v[32:35], v[144:147], v[92:95]
  ds_read_b64_tr_b16 v[20:21], v12 offset:10248
  ds_read_b64_tr_b16 v[22:23], v12 offset:12808
  v_mfma_f32_16x16x32_bf16 v[36:39], v[112:115], v[216:219], v[36:39]
  v_mfma_f32_16x16x32_bf16 v[76:79], v[112:115], v[144:147], v[76:79]
  ds_read_b64_tr_b16 v[24:25], v12 offset:10320
  ds_read_b64_tr_b16 v[26:27], v12 offset:12880
  v_mfma_f32_16x16x32_bf16 v[40:43], v[116:119], v[216:219], v[40:43]
  v_mfma_f32_16x16x32_bf16 v[80:83], v[116:119], v[144:147], v[80:83]
  ds_read_b64_tr_b16 v[28:29], v12 offset:10328
  ds_read_b64_tr_b16 v[30:31], v12 offset:12888
  v_mfma_f32_16x16x32_bf16 v[44:47], v[120:123], v[216:219], v[44:47]
  v_mfma_f32_16x16x32_bf16 v[84:87], v[120:123], v[144:147], v[84:87]
  ds_read_b64_tr_b16 v[32:33], v13 offset:10240
  ds_read_b64_tr_b16 v[34:35], v13 offset:12800
  v_mfma_f32_16x16x32_bf16 v[48:51], v[124:127], v[216:219], v[48:51]
  v_mfma_f32_16x16x32_bf16 v[88:91], v[124:127], v[144:147], v[88:91]
  ds_read_b64_tr_b16 v[112:113], v12 offset:15360
  ds_read_b64_tr_b16 v[114:115], v12 offset:17920
  v_mfma_f32_16x16x32_bf16 v[52:55], v[128:131], v[216:219], v[52:55]
  v_mfma_f32_16x16x32_bf16 v[92:95], v[128:131], v[144:147], v[92:95]
  ds_read_b64_tr_b16 v[116:117], v12 offset:15368
  ds_read_b64_tr_b16 v[118:119], v12 offset:17928
  s_waitcnt lgkmcnt(12)
  v_mfma_f32_16x16x32_bf16 v[36:39], v[16:19], v[220:223], v[36:39]
  v_mfma_f32_16x16x32_bf16 v[76:79], v[16:19], v[144:147], v[76:79]
  ds_read_b64_tr_b16 v[120:121], v12 offset:15440
  ds_read_b64_tr_b16 v[122:123], v12 offset:18000
  s_waitcnt lgkmcnt(12)
  v_mfma_f32_16x16x32_bf16 v[40:43], v[20:23], v[220:223], v[40:43]
  v_mfma_f32_16x16x32_bf16 v[80:83], v[20:23], v[144:147], v[80:83]
  ds_read_b64_tr_b16 v[124:125], v12 offset:15448
  ds_read_b64_tr_b16 v[126:127], v12 offset:18008
  s_waitcnt lgkmcnt(12)
  v_mfma_f32_16x16x32_bf16 v[44:47], v[24:27], v[220:223], v[44:47]
  v_mfma_f32_16x16x32_bf16 v[84:87], v[24:27], v[144:147], v[84:87]
  ds_read_b64_tr_b16 v[128:129], v13 offset:15360
  ds_read_b64_tr_b16 v[130:131], v13 offset:17920
  s_waitcnt lgkmcnt(12)
  v_mfma_f32_16x16x32_bf16 v[48:51], v[28:31], v[220:223], v[48:51]
  v_mfma_f32_16x16x32_bf16 v[88:91], v[28:31], v[144:147], v[88:91]
  ds_read_b64_tr_b16 v[16:17], v12 offset:20480
  ds_read_b64_tr_b16 v[18:19], v12 offset:23040
  s_waitcnt lgkmcnt(12)
  v_mfma_f32_16x16x32_bf16 v[52:55], v[32:35], v[220:223], v[52:55]
  v_mfma_f32_16x16x32_bf16 v[92:95], v[32:35], v[144:147], v[92:95]
  ds_read_b64_tr_b16 v[20:21], v12 offset:20488
  ds_read_b64_tr_b16 v[22:23], v12 offset:23048
  s_waitcnt lgkmcnt(12)
  v_mfma_f32_16x16x32_bf16 v[36:39], v[112:115], v[224:227], v[36:39]
  v_mfma_f32_16x16x32_bf16 v[76:79], v[112:115], v[144:147], v[76:79]
  ds_read_b64_tr_b16 v[24:25], v12 offset:20560
  ds_read_b64_tr_b16 v[26:27], v12 offset:23120
  s_waitcnt lgkmcnt(12)
  v_mfma_f32_16x16x32_bf16 v[40:43], v[116:119], v[224:227], v[40:43]
  v_mfma_f32_16x16x32_bf16 v[80:83], v[116:119], v[144:147], v[80:83]
  ds_read_b64_tr_b16 v[28:29], v12 offset:20568
  ds_read_b64_tr_b16 v[30:31], v12 offset:23128
  s_waitcnt lgkmcnt(12)
  v_mfma_f32_16x16x32_bf16 v[44:47], v[120:123], v[224:227], v[44:47]
  v_mfma_f32_16x16x32_bf16 v[84:87], v[120:123], v[144:147], v[84:87]
  ds_read_b64_tr_b16 v[32:33], v13 offset:20480
  ds_read_b64_tr_b16 v[34:35], v13 offset:23040
  s_waitcnt lgkmcnt(12)
  v_mfma_f32_16x16x32_bf16 v[48:51], v[124:127], v[224:227], v[48:51]
  v_mfma_f32_16x16x32_bf16 v[88:91], v[124:127], v[144:147], v[88:91]
  ds_read_b64_tr_b16 v[112:113], v12 offset:25600
  ds_read_b64_tr_b16 v[114:115], v12 offset:28160
  s_waitcnt lgkmcnt(12)
  v_mfma_f32_16x16x32_bf16 v[52:55], v[128:131], v[224:227], v[52:55]
  v_mfma_f32_16x16x32_bf16 v[92:95], v[128:131], v[144:147], v[92:95]
  ds_read_b64_tr_b16 v[116:117], v12 offset:25608
  ds_read_b64_tr_b16 v[118:119], v12 offset:28168
  s_waitcnt lgkmcnt(12)
  v_mfma_f32_16x16x32_bf16 v[36:39], v[16:19], v[228:231], v[36:39]
  v_mfma_f32_16x16x32_bf16 v[76:79], v[16:19], v[144:147], v[76:79]
  ds_read_b64_tr_b16 v[120:121], v12 offset:25680
  ds_read_b64_tr_b16 v[122:123], v12 offset:28240
  s_waitcnt lgkmcnt(12)
  v_mfma_f32_16x16x32_bf16 v[40:43], v[20:23], v[228:231], v[40:43]
  v_mfma_f32_16x16x32_bf16 v[80:83], v[20:23], v[144:147], v[80:83]
  ds_read_b64_tr_b16 v[124:125], v12 offset:25688
  ds_read_b64_tr_b16 v[126:127], v12 offset:28248
  s_waitcnt lgkmcnt(12)
  v_mfma_f32_16x16x32_bf16 v[44:47], v[24:27], v[228:231], v[44:47]
  v_mfma_f32_16x16x32_bf16 v[84:87], v[24:27], v[144:147], v[84:87]
  ds_read_b64_tr_b16 v[128:129], v13 offset:25600
  ds_read_b64_tr_b16 v[130:131], v13 offset:28160
  s_waitcnt lgkmcnt(12)
  v_mfma_f32_16x16x32_bf16 v[48:51], v[28:31], v[228:231], v[48:51]
  v_mfma_f32_16x16x32_bf16 v[88:91], v[28:31], v[144:147], v[88:91]
  ds_read_b64_tr_b16 v[16:17], v12 offset:30720
  ds_read_b64_tr_b16 v[18:19], v12 offset:33280
  s_waitcnt lgkmcnt(12)
  v_mfma_f32_16x16x32_bf16 v[52:55], v[32:35], v[228:231], v[52:55]
  v_mfma_f32_16x16x32_bf16 v[92:95], v[32:35], v[144:147], v[92:95]
  ds_read_b64_tr_b16 v[20:21], v12 offset:30728
  ds_read_b64_tr_b16 v[22:23], v12 offset:33288
  s_waitcnt lgkmcnt(12)
  v_mfma_f32_16x16x32_bf16 v[36:39], v[112:115], v[232:235], v[36:39]
  v_mfma_f32_16x16x32_bf16 v[76:79], v[112:115], v[144:147], v[76:79]
  ds_read_b64_tr_b16 v[24:25], v12 offset:30800
  ds_read_b64_tr_b16 v[26:27], v12 offset:33360
  s_waitcnt lgkmcnt(12)
  v_mfma_f32_16x16x32_bf16 v[40:43], v[116:119], v[232:235], v[40:43]
  v_mfma_f32_16x16x32_bf16 v[80:83], v[116:119], v[144:147], v[80:83]
  ds_read_b64_tr_b16 v[28:29], v12 offset:30808
  ds_read_b64_tr_b16 v[30:31], v12 offset:33368
  s_waitcnt lgkmcnt(12)
  v_mfma_f32_16x16x32_bf16 v[44:47], v[120:123], v[232:235], v[44:47]
  v_mfma_f32_16x16x32_bf16 v[84:87], v[120:123], v[144:147], v[84:87]
  ds_read_b64_tr_b16 v[32:33], v13 offset:30720
  ds_read_b64_tr_b16 v[34:35], v13 offset:33280
  s_waitcnt lgkmcnt(12)
  v_mfma_f32_16x16x32_bf16 v[48:51], v[124:127], v[232:235], v[48:51]
  v_mfma_f32_16x16x32_bf16 v[88:91], v[124:127], v[144:147], v[88:91]
  ds_read_b64_tr_b16 v[112:113], v12 offset:35840
  ds_read_b64_tr_b16 v[114:115], v12 offset:38400
  s_waitcnt lgkmcnt(12)
  v_mfma_f32_16x16x32_bf16 v[52:55], v[128:131], v[232:235], v[52:55]
  v_mfma_f32_16x16x32_bf16 v[92:95], v[128:131], v[144:147], v[92:95]
  ds_read_b64_tr_b16 v[116:117], v12 offset:35848
  ds_read_b64_tr_b16 v[118:119], v12 offset:38408
  s_waitcnt lgkmcnt(12)
  v_mfma_f32_16x16x32_bf16 v[36:39], v[16:19], v[236:239], v[36:39]
  v_mfma_f32_16x16x32_bf16 v[76:79], v[16:19], v[144:147], v[76:79]
  ds_read_b64_tr_b16 v[120:121], v12 offset:35920
  ds_read_b64_tr_b16 v[122:123], v12 offset:38480
  s_waitcnt lgkmcnt(12)
  v_mfma_f32_16x16x32_bf16 v[40:43], v[20:23], v[236:239], v[40:43]
  v_mfma_f32_16x16x32_bf16 v[80:83], v[20:23], v[144:147], v[80:83]
  ds_read_b64_tr_b16 v[124:125], v12 offset:35928
  ds_read_b64_tr_b16 v[126:127], v12 offset:38488
  s_waitcnt lgkmcnt(12)
  v_mfma_f32_16x16x32_bf16 v[44:47], v[24:27], v[236:239], v[44:47]
  v_mfma_f32_16x16x32_bf16 v[84:87], v[24:27], v[144:147], v[84:87]
  ds_read_b64_tr_b16 v[128:129], v13 offset:35840
  ds_read_b64_tr_b16 v[130:131], v13 offset:38400
  s_waitcnt lgkmcnt(12)
  v_mfma_f32_16x16x32_bf16 v[48:51], v[28:31], v[236:239], v[48:51]
  v_mfma_f32_16x16x32_bf16 v[88:91], v[28:31], v[144:147], v[88:91]
KF_LW18:
  ds_read_b128 v[64:67], v15 offset:0
  s_waitcnt lgkmcnt(0)
  v_min3_u32 v64, v64, v65, v66
  s_nop 0
  v_readfirstlane_b32 s42, v64
  s_nop 0
  s_cmp_ge_u32 s42, 7
  s_cbranch_scc0 KF_LW18
  ds_read_b64_tr_b16 v[16:17], v12 offset:40960
  ds_read_b64_tr_b16 v[18:19], v12 offset:43520
  v_mfma_f32_16x16x32_bf16 v[52:55], v[32:35], v[236:239], v[52:55]
  v_mfma_f32_16x16x32_bf16 v[92:95], v[32:35], v[144:147], v[92:95]
  ds_read_b64_tr_b16 v[20:21], v12 offset:40968
  ds_read_b64_tr_b16 v[22:23], v12 offset:43528
  v_mfma_f32_16x16x32_bf16 v[36:39], v[112:115], v[240:243], v[36:39]
  v_mfma_f32_16x16x32_bf16 v[76:79], v[112:115], v[144:147], v[76:79]
  ds_read_b64_tr_b16 v[24:25], v12 offset:41040
  ds_read_b64_tr_b16 v[26:27], v12 offset:43600
  v_mfma_f32_16x16x32_bf16 v[40:43], v[116:119], v[240:243], v[40:43]
  v_mfma_f32_16x16x32_bf16 v[80:83], v[116:119], v[144:147], v[80:83]
  ds_read_b64_tr_b16 v[28:29], v12 offset:41048
  ds_read_b64_tr_b16 v[30:31], v12 offset:43608
  v_mfma_f32_16x16x32_bf16 v[44:47], v[120:123], v[240:243], v[44:47]
  v_mfma_f32_16x16x32_bf16 v[84:87], v[120:123], v[144:147], v[84:87]
  ds_read_b64_tr_b16 v[32:33], v13 offset:40960
  ds_read_b64_tr_b16 v[34:35], v13 offset:43520
  v_mfma_f32_16x16x32_bf16 v[48:51], v[124:127], v[240:243], v[48:51]
  v_mfma_f32_16x16x32_bf16 v[88:91], v[124:127], v[144:147], v[88:91]
  ds_read_b64_tr_b16 v[112:113], v12 offset:46080
  ds_read_b64_tr_b16 v[114:115], v12 offset:48640
  v_mfma_f32_16x16x32_bf16 v[52:55], v[128:131], v[240:243], v[52:55]
  v_mfma_f32_16x16x32_bf16 v[92:95], v[128:131], v[144:147], v[92:95]
  ds_read_b64_tr_b16 v[116:117], v12 offset:46088
  ds_read_b64_tr_b16 v[118:119], v12 offset:48648
  s_waitcnt lgkmcnt(12)
  v_mfma_f32_16x16x32_bf16 v[36:39], v[16:19], v[244:247], v[36:39]
  v_mfma_f32_16x16x32_bf16 v[76:79], v[16:19], v[144:147], v[76:79]
  ds_read_b64_tr_b16 v[120:121], v12 offset:46160
  ds_read_b64_tr_b16 v[122:123], v12 offset:48720
  s_waitcnt lgkmcnt(12)
  v_mfma_f32_16x16x32_bf16 v[40:43], v[20:23], v[244:247], v[40:43]
  v_mfma_f32_16x16x32_bf16 v[80:83], v[20:23], v[144:147], v[80:83]
  ds_read_b64_tr_b16 v[124:125], v12 offset:46168
  ds_read_b64_tr_b16 v[126:127], v12 offset:48728
  s_waitcnt lgkmcnt(12)
  v_mfma_f32_16x16x32_bf16 v[44:47], v[24:27], v[244:247], v[44:47]
  v_mfma_f32_16x16x32_bf16 v[84:87], v[24:27], v[144:147], v[84:87]
  ds_read_b64_tr_b16 v[128:129], v13 offset:46080
  ds_read_b64_tr_b16 v[130:131], v13 offset:48640
  s_waitcnt lgkmcnt(12)
  v_mfma_f32_16x16x32_bf16 v[48:51], v[28:31], v[244:247], v[48:51]
  v_mfma_f32_16x16x32_bf16 v[88:91], v[28:31], v[144:147], v[88:91]
  s_waitcnt lgkmcnt(10)
  v_mfma_f32_16x16x32_bf16 v[52:55], v[32:35], v[244:247], v[52:55]
  v_mfma_f32_16x16x32_bf16 v[92:95], v[32:35], v[144:147], v[92:95]
  s_waitcnt lgkmcnt(8)
  v_mfma_f32_16x16x32_bf16 v[36:39], v[112:115], v[248:251], v[36:39]
  v_mfma_f32_16x16x32_bf16 v[76:79], v[112:115], v[144:147], v[76:79]
  s_waitcnt lgkmcnt(6)
  v_mfma_f32_16x16x32_bf16 v[40:43], v[116:119], v[248:251], v[40:43]
  v_mfma_f32_16x16x32_bf16 v[80:83], v[116:119], v[144:147], v[80:83]
  s_waitcnt lgkmcnt(4)
  v_mfma_f32_16x16x32_bf16 v[44:47], v[120:123], v[248:251], v[44:47]
  v_mfma_f32_16x16x32_bf16 v[84:87], v[120:123], v[144:147], v[84:87]
  s_waitcnt lgkmcnt(2)
  v_mfma_f32_16x16x32_bf16 v[48:51], v[124:127], v[248:251], v[48:51]
  v_mfma_f32_16x16x32_bf16 v[88:91], v[124:127], v[144:147], v[88:91]
  s_waitcnt lgkmcnt(0)
  v_mfma_f32_16x16x32_bf16 v[52:55], v[128:131], v[248:251], v[52:55]
  v_mfma_f32_16x16x32_bf16 v[92:95], v[128:131], v[144:147], v[92:95]
  v_mov_b32 v108, 0
  v_mov_b32 v109, 0
  v_fma_f32 v64, -v148, v76, v36
  v_fma_f32 v65, -v148, v77, v37
  v_fma_f32 v66, -v148, v78, v38
  v_fma_f32 v67, -v148, v79, v39
  v_mul_f32 v64, v64, v73
  v_mul_f32 v65, v65, v73
  v_mul_f32 v66, v66, v73
  v_mul_f32 v67, v67, v73
  v_cvt_pk_bf16_f32 v96, v64, v65
  v_cvt_pk_bf16_f32 v97, v66, v67
  v_fma_f32 v64, -v148, v80, v40
  v_fma_f32 v65, -v148, v81, v41
  v_fma_f32 v66, -v148, v82, v42
  v_fma_f32 v67, -v148, v83, v43
  v_mul_f32 v64, v64, v73
  v_mul_f32 v65, v65, v73
  v_mul_f32 v66, v66, v73
  v_mul_f32 v67, v67, v73
  v_cvt_pk_bf16_f32 v98, v64, v65
  v_cvt_pk_bf16_f32 v99, v66, v67
  v_fma_f32 v64, -v148, v84, v44
  v_fma_f32 v65, -v148, v85, v45
  v_fma_f32 v66, -v148, v86, v46
  v_fma_f32 v67, -v148, v87, v47
  v_mul_f32 v64, v64, v73
  v_mul_f32 v65, v65, v73
  v_mul_f32 v66, v66, v73
  v_mul_f32 v67, v67, v73
  v_cvt_pk_bf16_f32 v104, v64, v65
  v_cvt_pk_bf16_f32 v105, v66, v67
  v_fma_f32 v64, -v148, v88, v48
  v_fma_f32 v65, -v148, v89, v49
  v_fma_f32 v66, -v148, v90, v50
  v_fma_f32 v67, -v148, v91, v51
  v_mul_f32 v64, v64, v73
  v_mul_f32 v65, v65, v73
  v_mul_f32 v66, v66, v73
  v_mul_f32 v67, v67, v73
  v_cvt_pk_bf16_f32 v106, v64, v65
  v_cvt_pk_bf16_f32 v107, v66, v67
  v_fma_f32 v64, -v148, v92, v52
  v_fma_f32 v65, -v148, v93, v53
  v_fma_f32 v66, -v148, v94, v54
  v_fma_f32 v67, -v148, v95, v55
  v_mul_f32 v64, v64, v73
  v_mul_f32 v65, v65, v73
  v_mul_f32 v66, v66, v73
  v_mul_f32 v67, v67, v73
  v_cvt_pk_bf16_f32 v100, v64, v65
  v_cvt_pk_bf16_f32 v101, v66, v67
  s_nop 0
  v_permlane32_swap_b32 v100, v108
  v_permlane32_swap_b32 v101, v109
  v_and_b32 v5, 31, v2
  v_lshrrev_b32 v6, 5, v2
  v_lshlrev_b32 v144, 4, v2
  v_add_u32 v144, 102400, v144
  v_lshlrev_b32 v145, 3, v5
  v_add_u32 v145, 103424, v145
  v_min_u32 v146, 20, v5
  v_lshlrev_b32 v146, 4, v146
  v_mul_u32_u24 v7, 336, v6
  v_add_u32 v7, 103680, v7
  v_add_u32 v146, v146, v7
  v_cmp_eq_u32 vcc, 0, v6
  v_mov_b32 v7, 0x3f80
  s_nop 0
  v_cndmask_b32 v118, 0, v7, vcc
  v_cndmask_b32 v126, 0, v7, vcc
  v_mov_b32 v119, 0
  v_mov_b32 v127, 0
  v_mov_b32 v102, 0
  v_mov_b32 v103, 0
  v_mov_b32 v110, 0
  v_mov_b32 v111, 0
  v_mov_b32 v48, 0
  v_mov_b32 v49, 0
  v_mov_b32 v50, 0
  v_mov_b32 v51, 0
  v_mov_b32 v52, 0
  v_mov_b32 v53, 0
  v_mov_b32 v54, 0
  v_mov_b32 v55, 0
  v_mov_b32 v56, 0
  v_mov_b32 v57, 0
  v_mov_b32 v58, 0
  v_mov_b32 v59, 0
  v_mov_b32 v60, 0
  v_mov_b32 v61, 0
  v_mov_b32 v62, 0
  v_mov_b32 v63, 0
  v_mov_b32 v64, 0
  v_mov_b32 v65, 0
  v_mov_b32 v66, 0
  v_mov_b32 v67, 0
  v_mov_b32 v68, 0
  v_mov_b32 v69, 0
  v_mov_b32 v70, 0
  v_mov_b32 v71, 0
  v_mov_b32 v72, 0
  v_mov_b32 v73, 0
  v_mov_b32 v74, 0
  v_mov_b32 v75, 0
  v_mov_b32 v76, 0
  v_mov_b32 v77, 0
  v_mov_b32 v78, 0
  v_mov_b32 v79, 0
  v_mov_b32 v88, 0
  v_mov_b32 v89, 0
  v_mov_b32 v90, 0
  v_mov_b32 v91, 0
  v_mov_b32 v92, 0
  v_mov_b32 v93, 0
  v_mov_b32 v94, 0
  v_mov_b32 v95, 0
  v_mov_b32 v136, 0
  v_mov_b32 v137, 0
  v_mov_b32 v138, 0
  v_mov_b32 v139, 0
  v_mov_b32 v140, 0
  v_mov_b32 v141, 0
  v_mov_b32 v142, 0
  v_mov_b32 v143, 0
  s_barrier
  ds_read_b128 v[112:115], v144
  ds_read_b64 v[116:117], v145
  ds_read_b128 v[128:131], v146
  ds_read_b128 v[132:135], v146 offset:672
  s_mov_b32 s24, 0
  s_waitcnt lgkmcnt(2)
  v_mfma_f32_32x32x16_bf16 v[16:31], v[112:115], v[96:99], 0
  v_mfma_f32_32x32x16_bf16 v[16:31], v[116:119], v[100:103], v[16:31]
  v_mfma_f32_32x32x16_bf16 v[32:47], v[112:115], v[104:107], 0
  v_mfma_f32_32x32x16_bf16 v[32:47], v[116:119], v[108:111], v[32:47]
  s_nop 9
  v_max3_f32 v12, v16, v17, v18
  v_max3_f32 v12, v12, v19, v20
  v_max3_f32 v12, v12, v21, v22
  v_max3_f32 v12, v12, v23, v24
  v_max3_f32 v12, v12, v25, v26
  v_max3_f32 v12, v12, v27, v28
  v_max3_f32 v12, v12, v29, v30
  v_max_f32 v12, v12, v31
  v_mov_b32 v13, v12
  s_nop 1
  v_permlane32_swap_b32 v12, v13
  v_max_f32 v12, v12, v13
  v_cvt_pk_bf16_f32 v102, -v12, 0
  v_mfma_f32_32x32x16_bf16 v[16:31], v[112:115], v[96:99], 0
  s_nop 0
  v_mfma_f32_32x32x16_bf16 v[16:31], v[116:119], v[100:103], v[16:31]
  v_max3_f32 v10, v32, v33, v34
  v_max3_f32 v10, v10, v35, v36
  v_max3_f32 v10, v10, v37, v38
  v_max3_f32 v10, v10, v39, v40
  v_max3_f32 v10, v10, v41, v42
  v_max3_f32 v10, v10, v43, v44
  v_max3_f32 v10, v10, v45, v46
  v_max_f32 v10, v10, v47
  v_mov_b32 v11, v10
  s_nop 1
  v_permlane32_swap_b32 v10, v11
  v_max_f32 v10, v10, v11
  v_cvt_pk_bf16_f32 v110, -v10, 0
  s_waitcnt lgkmcnt(0)
KF_LOOP:
  v_mfma_f32_32x32x16_bf16 v[32:47], v[112:115], v[104:107], 0
  ds_read_b128 v[120:123], v144 offset:2688
  v_exp_f32 v16, v16
  ds_read_b64 v[124:125], v145 offset:2688
  v_exp_f32 v17, v17
  v_exp_f32 v18, v18
  v_exp_f32 v19, v19
  v_mfma_f32_32x32x16_bf16 v[32:47], v[116:119], v[108:111], v[32:47]
  v_exp_f32 v20, v20
  v_exp_f32 v21, v21
  v_cvt_pk_bf16_f32 v80, v16, v17
  v_exp_f32 v22, v22
  v_cvt_pk_bf16_f32 v81, v18, v19
  v_exp_f32 v23, v23
  v_mfma_f32_32x32x16_bf16 v[64:79], v[136:139], v[88:91], v[64:79]
  v_exp_f32 v24, v24
  v_exp_f32 v25, v25
  v_cvt_pk_bf16_f32 v82, v20, v21
  v_exp_f32 v26, v26
  v_cvt_pk_bf16_f32 v83, v22, v23
  v_exp_f32 v27, v27
  v_mfma_f32_32x32x16_bf16 v[64:79], v[140:143], v[92:95], v[64:79]
  v_exp_f32 v28, v28
  v_exp_f32 v29, v29
  v_cvt_pk_bf16_f32 v84, v24, v25
  v_exp_f32 v30, v30
  v_cvt_pk_bf16_f32 v85, v26, v27
  v_cvt_pk_bf16_f32 v86, v28, v29
  v_exp_f32 v31, v31
  s_waitcnt lgkmcnt(0)
  v_cvt_pk_bf16_f32 v87, v30, v31
  v_mfma_f32_32x32x16_bf16 v[16:31], v[120:123], v[96:99], 0
  ds_read_b128 v[136:139], v146 offset:2688
  v_exp_f32 v32, v32
  ds_read_b128 v[140:143], v146 offset:3360
  v_exp_f32 v33, v33
  v_exp_f32 v34, v34
  v_exp_f32 v35, v35
  v_mfma_f32_32x32x16_bf16 v[16:31], v[124:127], v[100:103], v[16:31]
  v_exp_f32 v36, v36
  v_exp_f32 v37, v37
  v_cvt_pk_bf16_f32 v88, v32, v33
  v_exp_f32 v38, v38
  v_cvt_pk_bf16_f32 v89, v34, v35
  v_exp_f32 v39, v39
  v_mfma_f32_32x32x16_bf16 v[48:63], v[128:131], v[80:83], v[48:63]
  v_exp_f32 v40, v40
  v_exp_f32 v41, v41
  v_cvt_pk_bf16_f32 v90, v36, v37
  v_exp_f32 v42, v42
  v_cvt_pk_bf16_f32 v91, v38, v39
  v_exp_f32 v43, v43
  v_mfma_f32_32x32x16_bf16 v[48:63], v[132:135], v[84:87], v[48:63]
  v_exp_f32 v44, v44
  v_exp_f32 v45, v45
  v_cvt_pk_bf16_f32 v92, v40, v41
  v_exp_f32 v46, v46
  v_cvt_pk_bf16_f32 v93, v42, v43
  v_cvt_pk_bf16_f32 v94, v44, v45
  v_exp_f32 v47, v47
  s_waitcnt lgkmcnt(0)
  v_cvt_pk_bf16_f32 v95, v46, v47
  v_mfma_f32_32x32x16_bf16 v[32:47], v[120:123], v[104:107], 0
  ds_read_b128 v[112:115], v144 offset:5376
  v_exp_f32 v16, v16
  ds_read_b64 v[116:117], v145 offset:5376
  v_exp_f32 v17, v17
  v_exp_f32 v18, v18
  v_exp_f32 v19, v19
  v_mfma_f32_32x32x16_bf16 v[32:47], v[124:127], v[108:111], v[32:47]
  v_exp_f32 v20, v20
  v_exp_f32 v21, v21
  v_cvt_pk_bf16_f32 v80, v16, v17
  v_exp_f32 v22, v22
  v_cvt_pk_bf16_f32 v81, v18, v19
  v_exp_f32 v23, v23
  v_mfma_f32_32x32x16_bf16 v[64:79], v[128:131], v[88:91], v[64:79]
  v_exp_f32 v24, v24
  v_exp_f32 v25, v25
  v_cvt_pk_bf16_f32 v82, v20, v21
  v_exp_f32 v26, v26
  v_cvt_pk_bf16_f32 v83, v22, v23
  v_exp_f32 v27, v27
  v_mfma_f32_32x32x16_bf16 v[64:79], v[132:135], v[92:95], v[64:79]
  v_exp_f32 v28, v28
  v_exp_f32 v29, v29
  v_cvt_pk_bf16_f32 v84, v24, v25
  v_exp_f32 v30, v30
  v_cvt_pk_bf16_f32 v85, v26, v27
  v_cvt_pk_bf16_f32 v86, v28, v29
  v_exp_f32 v31, v31
  s_waitcnt lgkmcnt(0)
  v_cvt_pk_bf16_f32 v87, v30, v31
  v_mfma_f32_32x32x16_bf16 v[16:31], v[112:115], v[96:99], 0
  ds_read_b128 v[128:131], v146 offset:5376
  v_exp_f32 v32, v32
  ds_read_b128 v[132:135], v146 offset:6048
  v_exp_f32 v33, v33
  v_exp_f32 v34, v34
  v_exp_f32 v35, v35
  v_mfma_f32_32x32x16_bf16 v[16:31], v[116:119], v[100:103], v[16:31]
  v_exp_f32 v36, v36
  v_exp_f32 v37, v37
  v_cvt_pk_bf16_f32 v88, v32, v33
  v_exp_f32 v38, v38
  v_cvt_pk_bf16_f32 v89, v34, v35
  v_exp_f32 v39, v39
  v_mfma_f32_32x32x16_bf16 v[48:63], v[136:139], v[80:83], v[48:63]
  v_exp_f32 v40, v40
  v_exp_f32 v41, v41
  v_cvt_pk_bf16_f32 v90, v36, v37
  v_exp_f32 v42, v42
  v_cvt_pk_bf16_f32 v91, v38, v39
  v_exp_f32 v43, v43
  v_mfma_f32_32x32x16_bf16 v[48:63], v[140:143], v[84:87], v[48:63]
  v_exp_f32 v44, v44
  v_exp_f32 v45, v45
  v_cvt_pk_bf16_f32 v92, v40, v41
  v_exp_f32 v46, v46
  v_cvt_pk_bf16_f32 v93, v42, v43
  v_cvt_pk_bf16_f32 v94, v44, v45
  v_exp_f32 v47, v47
  s_waitcnt lgkmcnt(0)
  v_cvt_pk_bf16_f32 v95, v46, v47
  v_mfma_f32_32x32x16_bf16 v[32:47], v[112:115], v[104:107], 0
  ds_read_b128 v[120:123], v144 offset:8064
  v_exp_f32 v16, v16
  ds_read_b64 v[124:125], v145 offset:8064
  v_exp_f32 v17, v17
  v_exp_f32 v18, v18
  v_exp_f32 v19, v19
  v_mfma_f32_32x32x16_bf16 v[32:47], v[116:119], v[108:111], v[32:47]
  v_exp_f32 v20, v20
  v_exp_f32 v21, v21
  v_cvt_pk_bf16_f32 v80, v16, v17
  v_exp_f32 v22, v22
  v_cvt_pk_bf16_f32 v81, v18, v19
  v_exp_f32 v23, v23
  v_mfma_f32_32x32x16_bf16 v[64:79], v[136:139], v[88:91], v[64:79]
  v_exp_f32 v24, v24
  v_exp_f32 v25, v25
  v_cvt_pk_bf16_f32 v82, v20, v21
  v_exp_f32 v26, v26
  v_cvt_pk_bf16_f32 v83, v22, v23
  v_exp_f32 v27, v27
  v_mfma_f32_32x32x16_bf16 v[64:79], v[140:143], v[92:95], v[64:79]
  v_exp_f32 v28, v28
  v_exp_f32 v29, v29
  v_cvt_pk_bf16_f32 v84, v24, v25
  v_exp_f32 v30, v30
  v_cvt_pk_bf16_f32 v85, v26, v27
  v_cvt_pk_bf16_f32 v86, v28, v29
  v_exp_f32 v31, v31
  s_waitcnt lgkmcnt(0)
  v_cvt_pk_bf16_f32 v87, v30, v31
  v_mfma_f32_32x32x16_bf16 v[16:31], v[120:123], v[96:99], 0
  ds_read_b128 v[136:139], v146 offset:8064
  v_exp_f32 v32, v32
  ds_read_b128 v[140:143], v146 offset:8736
  v_exp_f32 v33, v33
  v_exp_f32 v34, v34
  v_exp_f32 v35, v35
  v_mfma_f32_32x32x16_bf16 v[16:31], v[124:127], v[100:103], v[16:31]
  v_exp_f32 v36, v36
  v_exp_f32 v37, v37
  v_cvt_pk_bf16_f32 v88, v32, v33
  v_exp_f32 v38, v38
  v_cvt_pk_bf16_f32 v89, v34, v35
  v_exp_f32 v39, v39
  v_mfma_f32_32x32x16_bf16 v[48:63], v[128:131], v[80:83], v[48:63]
  v_exp_f32 v40, v40
  v_exp_f32 v41, v41
  v_cvt_pk_bf16_f32 v90, v36, v37
  v_exp_f32 v42, v42
  v_cvt_pk_bf16_f32 v91, v38, v39
  v_exp_f32 v43, v43
  v_mfma_f32_32x32x16_bf16 v[48:63], v[132:135], v[84:87], v[48:63]
  v_exp_f32 v44, v44
  v_exp_f32 v45, v45
  v_cvt_pk_bf16_f32 v92, v40, v41
  v_exp_f32 v46, v46
  v_cvt_pk_bf16_f32 v93, v42, v43
  v_cvt_pk_bf16_f32 v94, v44, v45
  v_exp_f32 v47, v47
  s_waitcnt lgkmcnt(0)
  v_cvt_pk_bf16_f32 v95, v46, v47
  v_mfma_f32_32x32x16_bf16 v[32:47], v[120:123], v[104:107], 0
  ds_read_b128 v[112:115], v144 offset:10752
  v_exp_f32 v16, v16
  ds_read_b64 v[116:117], v145 offset:10752
  v_exp_f32 v17, v17
  v_exp_f32 v18, v18
  v_exp_f32 v19, v19
  v_mfma_f32_32x32x16_bf16 v[32:47], v[124:127], v[108:111], v[32:47]
  v_exp_f32 v20, v20
  v_exp_f32 v21, v21
  v_cvt_pk_bf16_f32 v80, v16, v17
  v_exp_f32 v22, v22
  v_cvt_pk_bf16_f32 v81, v18, v19
  v_exp_f32 v23, v23
  v_mfma_f32_32x32x16_bf16 v[64:79], v[128:131], v[88:91], v[64:79]
  v_exp_f32 v24, v24
  v_exp_f32 v25, v25
  v_cvt_pk_bf16_f32 v82, v20, v21
  v_exp_f32 v26, v26
  v_cvt_pk_bf16_f32 v83, v22, v23
  v_exp_f32 v27, v27
  v_mfma_f32_32x32x16_bf16 v[64:79], v[132:135], v[92:95], v[64:79]
  v_exp_f32 v28, v28
  v_exp_f32 v29, v29
  v_cvt_pk_bf16_f32 v84, v24, v25
  v_exp_f32 v30, v30
  v_cvt_pk_bf16_f32 v85, v26, v27
  v_cvt_pk_bf16_f32 v86, v28, v29
  v_exp_f32 v31, v31
  s_waitcnt lgkmcnt(0)
  v_cvt_pk_bf16_f32 v87, v30, v31
  v_mfma_f32_32x32x16_bf16 v[16:31], v[112:115], v[96:99], 0
  ds_read_b128 v[128:131], v146 offset:10752
  v_exp_f32 v32, v32
  ds_read_b128 v[132:135], v146 offset:11424
  v_exp_f32 v33, v33
  v_exp_f32 v34, v34
  v_exp_f32 v35, v35
  v_mfma_f32_32x32x16_bf16 v[16:31], v[116:119], v[100:103], v[16:31]
  v_exp_f32 v36, v36
  v_exp_f32 v37, v37
  v_cvt_pk_bf16_f32 v88, v32, v33
  v_exp_f32 v38, v38
  v_cvt_pk_bf16_f32 v89, v34, v35
  v_exp_f32 v39, v39
  v_mfma_f32_32x32x16_bf16 v[48:63], v[136:139], v[80:83], v[48:63]
  v_exp_f32 v40, v40
  v_exp_f32 v41, v41
  v_cvt_pk_bf16_f32 v90, v36, v37
  v_exp_f32 v42, v42
  v_cvt_pk_bf16_f32 v91, v38, v39
  v_exp_f32 v43, v43
  v_mfma_f32_32x32x16_bf16 v[48:63], v[140:143], v[84:87], v[48:63]
  v_exp_f32 v44, v44
  v_exp_f32 v45, v45
  v_cvt_pk_bf16_f32 v92, v40, v41
  v_exp_f32 v46, v46
  v_cvt_pk_bf16_f32 v93, v42, v43
  v_cvt_pk_bf16_f32 v94, v44, v45
  v_exp_f32 v47, v47
  s_waitcnt lgkmcnt(0)
  v_cvt_pk_bf16_f32 v95, v46, v47
  v_mfma_f32_32x32x16_bf16 v[32:47], v[112:115], v[104:107], 0
  ds_read_b128 v[120:123], v144 offset:13440
  v_exp_f32 v16, v16
  ds_read_b64 v[124:125], v145 offset:13440
  v_exp_f32 v17, v17
  v_exp_f32 v18, v18
  v_exp_f32 v19, v19
  v_mfma_f32_32x32x16_bf16 v[32:47], v[116:119], v[108:111], v[32:47]
  v_exp_f32 v20, v20
  v_exp_f32 v21, v21
  v_cvt_pk_bf16_f32 v80, v16, v17
  v_exp_f32 v22, v22
  v_cvt_pk_bf16_f32 v81, v18, v19
  v_exp_f32 v23, v23
  v_mfma_f32_32x32x16_bf16 v[64:79], v[136:139], v[88:91], v[64:79]
  v_exp_f32 v24, v24
  v_exp_f32 v25, v25
  v_cvt_pk_bf16_f32 v82, v20, v21
  v_exp_f32 v26, v26
  v_cvt_pk_bf16_f32 v83, v22, v23
  v_exp_f32 v27, v27
  v_mfma_f32_32x32x16_bf16 v[64:79], v[140:143], v[92:95], v[64:79]
  v_exp_f32 v28, v28
  v_exp_f32 v29, v29
  v_cvt_pk_bf16_f32 v84, v24, v25
  v_exp_f32 v30, v30
  v_cvt_pk_bf16_f32 v85, v26, v27
  v_cvt_pk_bf16_f32 v86, v28, v29
  v_exp_f32 v31, v31
  s_waitcnt lgkmcnt(0)
  v_cvt_pk_bf16_f32 v87, v30, v31
  v_mfma_f32_32x32x16_bf16 v[16:31], v[120:123], v[96:99], 0
  ds_read_b128 v[136:139], v146 offset:13440
  v_exp_f32 v32, v32
  ds_read_b128 v[140:143], v146 offset:14112
  v_exp_f32 v33, v33
  v_exp_f32 v34, v34
  v_exp_f32 v35, v35
  v_mfma_f32_32x32x16_bf16 v[16:31], v[124:127], v[100:103], v[16:31]
  v_exp_f32 v36, v36
  v_exp_f32 v37, v37
  v_cvt_pk_bf16_f32 v88, v32, v33
  v_exp_f32 v38, v38
  v_cvt_pk_bf16_f32 v89, v34, v35
  v_exp_f32 v39, v39
  v_mfma_f32_32x32x16_bf16 v[48:63], v[128:131], v[80:83], v[48:63]
  v_exp_f32 v40, v40
  v_exp_f32 v41, v41
  v_cvt_pk_bf16_f32 v90, v36, v37
  v_exp_f32 v42, v42
  v_cvt_pk_bf16_f32 v91, v38, v39
  v_exp_f32 v43, v43
  v_mfma_f32_32x32x16_bf16 v[48:63], v[132:135], v[84:87], v[48:63]
  v_exp_f32 v44, v44
  v_exp_f32 v45, v45
  v_cvt_pk_bf16_f32 v92, v40, v41
  v_exp_f32 v46, v46
  v_cvt_pk_bf16_f32 v93, v42, v43
  v_cvt_pk_bf16_f32 v94, v44, v45
  v_exp_f32 v47, v47
  s_waitcnt lgkmcnt(0)
  v_cvt_pk_bf16_f32 v95, v46, v47
  v_mfma_f32_32x32x16_bf16 v[32:47], v[120:123], v[104:107], 0
  ds_read_b128 v[112:115], v144 offset:16128
  v_exp_f32 v16, v16
  ds_read_b64 v[116:117], v145 offset:16128
  v_exp_f32 v17, v17
  v_exp_f32 v18, v18
  v_exp_f32 v19, v19
  v_mfma_f32_32x32x16_bf16 v[32:47], v[124:127], v[108:111], v[32:47]
  v_exp_f32 v20, v20
  v_exp_f32 v21, v21
  v_cvt_pk_bf16_f32 v80, v16, v17
  v_exp_f32 v22, v22
  v_cvt_pk_bf16_f32 v81, v18, v19
  v_exp_f32 v23, v23
  v_mfma_f32_32x32x16_bf16 v[64:79], v[128:131], v[88:91], v[64:79]
  v_exp_f32 v24, v24
  v_exp_f32 v25, v25
  v_cvt_pk_bf16_f32 v82, v20, v21
  v_exp_f32 v26, v26
  v_cvt_pk_bf16_f32 v83, v22, v23
  v_exp_f32 v27, v27
  v_mfma_f32_32x32x16_bf16 v[64:79], v[132:135], v[92:95], v[64:79]
  v_exp_f32 v28, v28
  v_exp_f32 v29, v29
  v_cvt_pk_bf16_f32 v84, v24, v25
  v_exp_f32 v30, v30
  v_cvt_pk_bf16_f32 v85, v26, v27
  v_cvt_pk_bf16_f32 v86, v28, v29
  v_exp_f32 v31, v31
  s_waitcnt lgkmcnt(0)
  v_cvt_pk_bf16_f32 v87, v30, v31
  v_mfma_f32_32x32x16_bf16 v[16:31], v[112:115], v[96:99], 0
  ds_read_b128 v[128:131], v146 offset:16128
  v_exp_f32 v32, v32
  ds_read_b128 v[132:135], v146 offset:16800
  v_exp_f32 v33, v33
  v_exp_f32 v34, v34
  v_exp_f32 v35, v35
  v_mfma_f32_32x32x16_bf16 v[16:31], v[116:119], v[100:103], v[16:31]
  v_exp_f32 v36, v36
  v_exp_f32 v37, v37
  v_cvt_pk_bf16_f32 v88, v32, v33
  v_exp_f32 v38, v38
  v_cvt_pk_bf16_f32 v89, v34, v35
  v_exp_f32 v39, v39
  v_mfma_f32_32x32x16_bf16 v[48:63], v[136:139], v[80:83], v[48:63]
  v_exp_f32 v40, v40
  v_exp_f32 v41, v41
  v_cvt_pk_bf16_f32 v90, v36, v37
  v_exp_f32 v42, v42
  v_cvt_pk_bf16_f32 v91, v38, v39
  v_exp_f32 v43, v43
  v_mfma_f32_32x32x16_bf16 v[48:63], v[140:143], v[84:87], v[48:63]
  v_exp_f32 v44, v44
  v_exp_f32 v45, v45
  v_cvt_pk_bf16_f32 v92, v40, v41
  v_exp_f32 v46, v46
  v_cvt_pk_bf16_f32 v93, v42, v43
  v_cvt_pk_bf16_f32 v94, v44, v45
  v_exp_f32 v47, v47
  s_waitcnt lgkmcnt(0)
  v_cvt_pk_bf16_f32 v95, v46, v47
  v_mfma_f32_32x32x16_bf16 v[32:47], v[112:115], v[104:107], 0
  ds_read_b128 v[120:123], v144 offset:18816
  v_exp_f32 v16, v16
  ds_read_b64 v[124:125], v145 offset:18816
  v_exp_f32 v17, v17
  v_exp_f32 v18, v18
  v_exp_f32 v19, v19
  v_mfma_f32_32x32x16_bf16 v[32:47], v[116:119], v[108:111], v[32:47]
  v_exp_f32 v20, v20
  v_exp_f32 v21, v21
  v_cvt_pk_bf16_f32 v80, v16, v17
  v_exp_f32 v22, v22
  v_cvt_pk_bf16_f32 v81, v18, v19
  v_exp_f32 v23, v23
  v_mfma_f32_32x32x16_bf16 v[64:79], v[136:139], v[88:91], v[64:79]
  v_exp_f32 v24, v24
  v_exp_f32 v25, v25
  v_cvt_pk_bf16_f32 v82, v20, v21
  v_exp_f32 v26, v26
  v_cvt_pk_bf16_f32 v83, v22, v23
  v_exp_f32 v27, v27
  v_mfma_f32_32x32x16_bf16 v[64:79], v[140:143], v[92:95], v[64:79]
  v_exp_f32 v28, v28
  v_exp_f32 v29, v29
  v_cvt_pk_bf16_f32 v84, v24, v25
  v_exp_f32 v30, v30
  v_cvt_pk_bf16_f32 v85, v26, v27
  v_cvt_pk_bf16_f32 v86, v28, v29
  v_exp_f32 v31, v31
  s_waitcnt lgkmcnt(0)
  v_cvt_pk_bf16_f32 v87, v30, v31
  v_mfma_f32_32x32x16_bf16 v[16:31], v[120:123], v[96:99], 0
  ds_read_b128 v[136:139], v146 offset:18816
  v_exp_f32 v32, v32
  ds_read_b128 v[140:143], v146 offset:19488
  v_exp_f32 v33, v33
  v_exp_f32 v34, v34
  v_exp_f32 v35, v35
  v_mfma_f32_32x32x16_bf16 v[16:31], v[124:127], v[100:103], v[16:31]
  v_exp_f32 v36, v36
  v_exp_f32 v37, v37
  v_cvt_pk_bf16_f32 v88, v32, v33
  v_exp_f32 v38, v38
  v_cvt_pk_bf16_f32 v89, v34, v35
  v_exp_f32 v39, v39
  v_mfma_f32_32x32x16_bf16 v[48:63], v[128:131], v[80:83], v[48:63]
  v_exp_f32 v40, v40
  v_exp_f32 v41, v41
  v_cvt_pk_bf16_f32 v90, v36, v37
  v_exp_f32 v42, v42
  v_cvt_pk_bf16_f32 v91, v38, v39
  v_exp_f32 v43, v43
  v_mfma_f32_32x32x16_bf16 v[48:63], v[132:135], v[84:87], v[48:63]
  v_exp_f32 v44, v44
  v_exp_f32 v45, v45
  v_cvt_pk_bf16_f32 v92, v40, v41
  v_exp_f32 v46, v46
  v_cvt_pk_bf16_f32 v93, v42, v43
  v_cvt_pk_bf16_f32 v94, v44, v45
  v_exp_f32 v47, v47
  s_waitcnt lgkmcnt(0)
  v_cvt_pk_bf16_f32 v95, v46, v47
  s_barrier
  v_mfma_f32_32x32x16_bf16 v[32:47], v[120:123], v[104:107], 0
  ds_read_b128 v[112:115], v144 offset:21504
  v_exp_f32 v16, v16
  ds_read_b64 v[116:117], v145 offset:21504
  v_exp_f32 v17, v17
  v_exp_f32 v18, v18
  v_exp_f32 v19, v19
  v_mfma_f32_32x32x16_bf16 v[32:47], v[124:127], v[108:111], v[32:47]
  v_exp_f32 v20, v20
  v_exp_f32 v21, v21
  v_cvt_pk_bf16_f32 v80, v16, v17
  v_exp_f32 v22, v22
  v_cvt_pk_bf16_f32 v81, v18, v19
  v_exp_f32 v23, v23
  v_mfma_f32_32x32x16_bf16 v[64:79], v[128:131], v[88:91], v[64:79]
  v_exp_f32 v24, v24
  v_exp_f32 v25, v25
  v_cvt_pk_bf16_f32 v82, v20, v21
  v_exp_f32 v26, v26
  v_cvt_pk_bf16_f32 v83, v22, v23
  v_exp_f32 v27, v27
  v_mfma_f32_32x32x16_bf16 v[64:79], v[132:135], v[92:95], v[64:79]
  v_exp_f32 v28, v28
  v_exp_f32 v29, v29
  v_cvt_pk_bf16_f32 v84, v24, v25
  v_exp_f32 v30, v30
  v_cvt_pk_bf16_f32 v85, v26, v27
  v_cvt_pk_bf16_f32 v86, v28, v29
  v_exp_f32 v31, v31
  s_waitcnt lgkmcnt(0)
  v_cvt_pk_bf16_f32 v87, v30, v31
  v_mfma_f32_32x32x16_bf16 v[16:31], v[112:115], v[96:99], 0
  ds_read_b128 v[128:131], v146 offset:21504
  v_exp_f32 v32, v32
  ds_read_b128 v[132:135], v146 offset:22176
  v_exp_f32 v33, v33
  v_exp_f32 v34, v34
  v_exp_f32 v35, v35
  v_mfma_f32_32x32x16_bf16 v[16:31], v[116:119], v[100:103], v[16:31]
  v_exp_f32 v36, v36
  v_exp_f32 v37, v37
  v_cvt_pk_bf16_f32 v88, v32, v33
  v_exp_f32 v38, v38
  v_cvt_pk_bf16_f32 v89, v34, v35
  v_exp_f32 v39, v39
  v_mfma_f32_32x32x16_bf16 v[48:63], v[136:139], v[80:83], v[48:63]
  v_exp_f32 v40, v40
  v_exp_f32 v41, v41
  v_cvt_pk_bf16_f32 v90, v36, v37
  v_exp_f32 v42, v42
  v_cvt_pk_bf16_f32 v91, v38, v39
  v_exp_f32 v43, v43
  v_mfma_f32_32x32x16_bf16 v[48:63], v[140:143], v[84:87], v[48:63]
  v_exp_f32 v44, v44
  v_exp_f32 v45, v45
  v_cvt_pk_bf16_f32 v92, v40, v41
  v_exp_f32 v46, v46
  v_cvt_pk_bf16_f32 v93, v42, v43
  v_cvt_pk_bf16_f32 v94, v44, v45
  v_exp_f32 v47, v47
  s_waitcnt lgkmcnt(0)
  v_cvt_pk_bf16_f32 v95, v46, v47
  v_mfma_f32_32x32x16_bf16 v[32:47], v[112:115], v[104:107], 0
  ds_read_b128 v[120:123], v144 offset:24192
  v_exp_f32 v16, v16
  ds_read_b64 v[124:125], v145 offset:24192
  v_exp_f32 v17, v17
  v_exp_f32 v18, v18
  v_exp_f32 v19, v19
  v_mfma_f32_32x32x16_bf16 v[32:47], v[116:119], v[108:111], v[32:47]
  v_exp_f32 v20, v20
  v_exp_f32 v21, v21
  v_cvt_pk_bf16_f32 v80, v16, v17
  v_exp_f32 v22, v22
  v_cvt_pk_bf16_f32 v81, v18, v19
  v_exp_f32 v23, v23
  v_mfma_f32_32x32x16_bf16 v[64:79], v[136:139], v[88:91], v[64:79]
  v_exp_f32 v24, v24
  v_exp_f32 v25, v25
  v_cvt_pk_bf16_f32 v82, v20, v21
  v_exp_f32 v26, v26
  v_cvt_pk_bf16_f32 v83, v22, v23
  v_exp_f32 v27, v27
  v_mfma_f32_32x32x16_bf16 v[64:79], v[140:143], v[92:95], v[64:79]
  v_exp_f32 v28, v28
  v_exp_f32 v29, v29
  v_cvt_pk_bf16_f32 v84, v24, v25
  v_exp_f32 v30, v30
  v_cvt_pk_bf16_f32 v85, v26, v27
  v_cvt_pk_bf16_f32 v86, v28, v29
  v_exp_f32 v31, v31
  s_waitcnt lgkmcnt(0)
  v_cvt_pk_bf16_f32 v87, v30, v31
  v_mfma_f32_32x32x16_bf16 v[16:31], v[120:123], v[96:99], 0
  ds_read_b128 v[136:139], v146 offset:24192
  v_exp_f32 v32, v32
  ds_read_b128 v[140:143], v146 offset:24864
  v_exp_f32 v33, v33
  v_exp_f32 v34, v34
  v_exp_f32 v35, v35
  v_mfma_f32_32x32x16_bf16 v[16:31], v[124:127], v[100:103], v[16:31]
  v_exp_f32 v36, v36
  v_exp_f32 v37, v37
  v_cvt_pk_bf16_f32 v88, v32, v33
  v_exp_f32 v38, v38
  v_cvt_pk_bf16_f32 v89, v34, v35
  v_exp_f32 v39, v39
  v_mfma_f32_32x32x16_bf16 v[48:63], v[128:131], v[80:83], v[48:63]
  v_exp_f32 v40, v40
  v_exp_f32 v41, v41
  v_cvt_pk_bf16_f32 v90, v36, v37
  v_exp_f32 v42, v42
  v_cvt_pk_bf16_f32 v91, v38, v39
  v_exp_f32 v43, v43
  v_mfma_f32_32x32x16_bf16 v[48:63], v[132:135], v[84:87], v[48:63]
  v_exp_f32 v44, v44
  v_exp_f32 v45, v45
  v_cvt_pk_bf16_f32 v92, v40, v41
  v_exp_f32 v46, v46
  v_cvt_pk_bf16_f32 v93, v42, v43
  v_cvt_pk_bf16_f32 v94, v44, v45
  v_exp_f32 v47, v47
  s_waitcnt lgkmcnt(0)
  v_cvt_pk_bf16_f32 v95, v46, v47
  v_mfma_f32_32x32x16_bf16 v[32:47], v[120:123], v[104:107], 0
  ds_read_b128 v[112:115], v144 offset:26880
  v_exp_f32 v16, v16
  ds_read_b64 v[116:117], v145 offset:26880
  v_exp_f32 v17, v17
  v_exp_f32 v18, v18
  v_exp_f32 v19, v19
  v_mfma_f32_32x32x16_bf16 v[32:47], v[124:127], v[108:111], v[32:47]
  v_exp_f32 v20, v20
  v_exp_f32 v21, v21
  v_cvt_pk_bf16_f32 v80, v16, v17
  v_exp_f32 v22, v22
  v_cvt_pk_bf16_f32 v81, v18, v19
  v_exp_f32 v23, v23
  v_mfma_f32_32x32x16_bf16 v[64:79], v[128:131], v[88:91], v[64:79]
  v_exp_f32 v24, v24
  v_exp_f32 v25, v25
  v_cvt_pk_bf16_f32 v82, v20, v21
  v_exp_f32 v26, v26
  v_cvt_pk_bf16_f32 v83, v22, v23
  v_exp_f32 v27, v27
  v_mfma_f32_32x32x16_bf16 v[64:79], v[132:135], v[92:95], v[64:79]
  v_exp_f32 v28, v28
  v_exp_f32 v29, v29
  v_cvt_pk_bf16_f32 v84, v24, v25
  v_exp_f32 v30, v30
  v_cvt_pk_bf16_f32 v85, v26, v27
  v_cvt_pk_bf16_f32 v86, v28, v29
  v_exp_f32 v31, v31
  s_waitcnt lgkmcnt(0)
  v_cvt_pk_bf16_f32 v87, v30, v31
  v_mfma_f32_32x32x16_bf16 v[16:31], v[112:115], v[96:99], 0
  ds_read_b128 v[128:131], v146 offset:26880
  v_exp_f32 v32, v32
  ds_read_b128 v[132:135], v146 offset:27552
  v_exp_f32 v33, v33
  v_exp_f32 v34, v34
  v_exp_f32 v35, v35
  v_mfma_f32_32x32x16_bf16 v[16:31], v[116:119], v[100:103], v[16:31]
  v_exp_f32 v36, v36
  v_exp_f32 v37, v37
  v_cvt_pk_bf16_f32 v88, v32, v33
  v_exp_f32 v38, v38
  v_cvt_pk_bf16_f32 v89, v34, v35
  v_exp_f32 v39, v39
  v_mfma_f32_32x32x16_bf16 v[48:63], v[136:139], v[80:83], v[48:63]
  v_exp_f32 v40, v40
  v_exp_f32 v41, v41
  v_cvt_pk_bf16_f32 v90, v36, v37
  v_exp_f32 v42, v42
  v_cvt_pk_bf16_f32 v91, v38, v39
  v_exp_f32 v43, v43
  v_mfma_f32_32x32x16_bf16 v[48:63], v[140:143], v[84:87], v[48:63]
  v_exp_f32 v44, v44
  v_exp_f32 v45, v45
  v_cvt_pk_bf16_f32 v92, v40, v41
  v_exp_f32 v46, v46
  v_cvt_pk_bf16_f32 v93, v42, v43
  v_cvt_pk_bf16_f32 v94, v44, v45
  v_exp_f32 v47, v47
  s_waitcnt lgkmcnt(0)
  v_cvt_pk_bf16_f32 v95, v46, v47
  v_mfma_f32_32x32x16_bf16 v[32:47], v[112:115], v[104:107], 0
  ds_read_b128 v[120:123], v144 offset:29568
  v_exp_f32 v16, v16
  ds_read_b64 v[124:125], v145 offset:29568
  v_exp_f32 v17, v17
  v_exp_f32 v18, v18
  v_exp_f32 v19, v19
  v_mfma_f32_32x32x16_bf16 v[32:47], v[116:119], v[108:111], v[32:47]
  v_exp_f32 v20, v20
  v_exp_f32 v21, v21
  v_cvt_pk_bf16_f32 v80, v16, v17
  v_exp_f32 v22, v22
  v_cvt_pk_bf16_f32 v81, v18, v19
  v_exp_f32 v23, v23
  v_mfma_f32_32x32x16_bf16 v[64:79], v[136:139], v[88:91], v[64:79]
  v_exp_f32 v24, v24
  v_exp_f32 v25, v25
  v_cvt_pk_bf16_f32 v82, v20, v21
  v_exp_f32 v26, v26
  v_cvt_pk_bf16_f32 v83, v22, v23
  v_exp_f32 v27, v27
  v_mfma_f32_32x32x16_bf16 v[64:79], v[140:143], v[92:95], v[64:79]
  v_exp_f32 v28, v28
  v_exp_f32 v29, v29
  v_cvt_pk_bf16_f32 v84, v24, v25
  v_exp_f32 v30, v30
  v_cvt_pk_bf16_f32 v85, v26, v27
  v_cvt_pk_bf16_f32 v86, v28, v29
  v_exp_f32 v31, v31
  s_waitcnt lgkmcnt(0)
  v_cvt_pk_bf16_f32 v87, v30, v31
  v_mfma_f32_32x32x16_bf16 v[16:31], v[120:123], v[96:99], 0
  ds_read_b128 v[136:139], v146 offset:29568
  v_exp_f32 v32, v32
  ds_read_b128 v[140:143], v146 offset:30240
  v_exp_f32 v33, v33
  v_exp_f32 v34, v34
  v_exp_f32 v35, v35
  v_mfma_f32_32x32x16_bf16 v[16:31], v[124:127], v[100:103], v[16:31]
  v_exp_f32 v36, v36
  v_exp_f32 v37, v37
  v_cvt_pk_bf16_f32 v88, v32, v33
  v_exp_f32 v38, v38
  v_cvt_pk_bf16_f32 v89, v34, v35
  v_exp_f32 v39, v39
  v_mfma_f32_32x32x16_bf16 v[48:63], v[128:131], v[80:83], v[48:63]
  v_exp_f32 v40, v40
  v_exp_f32 v41, v41
  v_cvt_pk_bf16_f32 v90, v36, v37
  v_exp_f32 v42, v42
  v_cvt_pk_bf16_f32 v91, v38, v39
  v_exp_f32 v43, v43
  v_mfma_f32_32x32x16_bf16 v[48:63], v[132:135], v[84:87], v[48:63]
  v_exp_f32 v44, v44
  v_exp_f32 v45, v45
  v_cvt_pk_bf16_f32 v92, v40, v41
  v_exp_f32 v46, v46
  v_cvt_pk_bf16_f32 v93, v42, v43
  v_cvt_pk_bf16_f32 v94, v44, v45
  v_exp_f32 v47, v47
  s_waitcnt lgkmcnt(0)
  v_cvt_pk_bf16_f32 v95, v46, v47
  v_mfma_f32_32x32x16_bf16 v[32:47], v[120:123], v[104:107], 0
  ds_read_b128 v[112:115], v144 offset:32256
  v_exp_f32 v16, v16
  ds_read_b64 v[116:117], v145 offset:32256
  v_exp_f32 v17, v17
  v_exp_f32 v18, v18
  v_exp_f32 v19, v19
  v_mfma_f32_32x32x16_bf16 v[32:47], v[124:127], v[108:111], v[32:47]
  v_exp_f32 v20, v20
  v_exp_f32 v21, v21
  v_cvt_pk_bf16_f32 v80, v16, v17
  v_exp_f32 v22, v22
  v_cvt_pk_bf16_f32 v81, v18, v19
  v_exp_f32 v23, v23
  v_mfma_f32_32x32x16_bf16 v[64:79], v[128:131], v[88:91], v[64:79]
  v_exp_f32 v24, v24
  v_exp_f32 v25, v25
  v_cvt_pk_bf16_f32 v82, v20, v21
  v_exp_f32 v26, v26
  v_cvt_pk_bf16_f32 v83, v22, v23
  v_exp_f32 v27, v27
  v_mfma_f32_32x32x16_bf16 v[64:79], v[132:135], v[92:95], v[64:79]
  v_exp_f32 v28, v28
  v_exp_f32 v29, v29
  v_cvt_pk_bf16_f32 v84, v24, v25
  v_exp_f32 v30, v30
  v_cvt_pk_bf16_f32 v85, v26, v27
  v_cvt_pk_bf16_f32 v86, v28, v29
  v_exp_f32 v31, v31
  s_waitcnt lgkmcnt(0)
  v_cvt_pk_bf16_f32 v87, v30, v31
  v_mfma_f32_32x32x16_bf16 v[16:31], v[112:115], v[96:99], 0
  ds_read_b128 v[128:131], v146 offset:32256
  v_exp_f32 v32, v32
  ds_read_b128 v[132:135], v146 offset:32928
  v_exp_f32 v33, v33
  v_exp_f32 v34, v34
  v_exp_f32 v35, v35
  v_mfma_f32_32x32x16_bf16 v[16:31], v[116:119], v[100:103], v[16:31]
  v_exp_f32 v36, v36
  v_exp_f32 v37, v37
  v_cvt_pk_bf16_f32 v88, v32, v33
  v_exp_f32 v38, v38
  v_cvt_pk_bf16_f32 v89, v34, v35
  v_exp_f32 v39, v39
  v_mfma_f32_32x32x16_bf16 v[48:63], v[136:139], v[80:83], v[48:63]
  v_exp_f32 v40, v40
  v_exp_f32 v41, v41
  v_cvt_pk_bf16_f32 v90, v36, v37
  v_exp_f32 v42, v42
  v_cvt_pk_bf16_f32 v91, v38, v39
  v_exp_f32 v43, v43
  v_mfma_f32_32x32x16_bf16 v[48:63], v[140:143], v[84:87], v[48:63]
  v_exp_f32 v44, v44
  v_exp_f32 v45, v45
  v_cvt_pk_bf16_f32 v92, v40, v41
  v_exp_f32 v46, v46
  v_cvt_pk_bf16_f32 v93, v42, v43
  v_cvt_pk_bf16_f32 v94, v44, v45
  v_exp_f32 v47, v47
  s_waitcnt lgkmcnt(0)
  v_cvt_pk_bf16_f32 v95, v46, v47
  v_mfma_f32_32x32x16_bf16 v[32:47], v[112:115], v[104:107], 0
  ds_read_b128 v[120:123], v144 offset:34944
  v_exp_f32 v16, v16
  ds_read_b64 v[124:125], v145 offset:34944
  v_exp_f32 v17, v17
  v_exp_f32 v18, v18
  v_exp_f32 v19, v19
  v_mfma_f32_32x32x16_bf16 v[32:47], v[116:119], v[108:111], v[32:47]
  v_exp_f32 v20, v20
  v_exp_f32 v21, v21
  v_cvt_pk_bf16_f32 v80, v16, v17
  v_exp_f32 v22, v22
  v_cvt_pk_bf16_f32 v81, v18, v19
  v_exp_f32 v23, v23
  v_mfma_f32_32x32x16_bf16 v[64:79], v[136:139], v[88:91], v[64:79]
  v_exp_f32 v24, v24
  v_exp_f32 v25, v25
  v_cvt_pk_bf16_f32 v82, v20, v21
  v_exp_f32 v26, v26
  v_cvt_pk_bf16_f32 v83, v22, v23
  v_exp_f32 v27, v27
  v_mfma_f32_32x32x16_bf16 v[64:79], v[140:143], v[92:95], v[64:79]
  v_exp_f32 v28, v28
  v_exp_f32 v29, v29
  v_cvt_pk_bf16_f32 v84, v24, v25
  v_exp_f32 v30, v30
  v_cvt_pk_bf16_f32 v85, v26, v27
  v_cvt_pk_bf16_f32 v86, v28, v29
  v_exp_f32 v31, v31
  s_waitcnt lgkmcnt(0)
  v_cvt_pk_bf16_f32 v87, v30, v31
  v_mfma_f32_32x32x16_bf16 v[16:31], v[120:123], v[96:99], 0
  ds_read_b128 v[136:139], v146 offset:34944
  v_exp_f32 v32, v32
  ds_read_b128 v[140:143], v146 offset:35616
  v_exp_f32 v33, v33
  v_exp_f32 v34, v34
  v_exp_f32 v35, v35
  v_mfma_f32_32x32x16_bf16 v[16:31], v[124:127], v[100:103], v[16:31]
  v_exp_f32 v36, v36
  v_exp_f32 v37, v37
  v_cvt_pk_bf16_f32 v88, v32, v33
  v_exp_f32 v38, v38
  v_cvt_pk_bf16_f32 v89, v34, v35
  v_exp_f32 v39, v39
  v_mfma_f32_32x32x16_bf16 v[48:63], v[128:131], v[80:83], v[48:63]
  v_exp_f32 v40, v40
  v_exp_f32 v41, v41
  v_cvt_pk_bf16_f32 v90, v36, v37
  v_exp_f32 v42, v42
  v_cvt_pk_bf16_f32 v91, v38, v39
  v_exp_f32 v43, v43
  v_mfma_f32_32x32x16_bf16 v[48:63], v[132:135], v[84:87], v[48:63]
  v_exp_f32 v44, v44
  v_exp_f32 v45, v45
  v_cvt_pk_bf16_f32 v92, v40, v41
  v_exp_f32 v46, v46
  v_cvt_pk_bf16_f32 v93, v42, v43
  v_cvt_pk_bf16_f32 v94, v44, v45
  v_exp_f32 v47, v47
  s_waitcnt lgkmcnt(0)
  v_cvt_pk_bf16_f32 v95, v46, v47
  v_mfma_f32_32x32x16_bf16 v[32:47], v[120:123], v[104:107], 0
  ds_read_b128 v[112:115], v144 offset:37632
  v_exp_f32 v16, v16
  ds_read_b64 v[116:117], v145 offset:37632
  v_exp_f32 v17, v17
  v_exp_f32 v18, v18
  v_exp_f32 v19, v19
  v_mfma_f32_32x32x16_bf16 v[32:47], v[124:127], v[108:111], v[32:47]
  v_exp_f32 v20, v20
  v_exp_f32 v21, v21
  v_cvt_pk_bf16_f32 v80, v16, v17
  v_exp_f32 v22, v22
  v_cvt_pk_bf16_f32 v81, v18, v19
  v_exp_f32 v23, v23
  v_mfma_f32_32x32x16_bf16 v[64:79], v[128:131], v[88:91], v[64:79]
  v_exp_f32 v24, v24
  v_exp_f32 v25, v25
  v_cvt_pk_bf16_f32 v82, v20, v21
  v_exp_f32 v26, v26
  v_cvt_pk_bf16_f32 v83, v22, v23
  v_exp_f32 v27, v27
  v_mfma_f32_32x32x16_bf16 v[64:79], v[132:135], v[92:95], v[64:79]
  v_exp_f32 v28, v28
  v_exp_f32 v29, v29
  v_cvt_pk_bf16_f32 v84, v24, v25
  v_exp_f32 v30, v30
  v_cvt_pk_bf16_f32 v85, v26, v27
  v_cvt_pk_bf16_f32 v86, v28, v29
  v_exp_f32 v31, v31
  s_waitcnt lgkmcnt(0)
  v_cvt_pk_bf16_f32 v87, v30, v31
  v_mfma_f32_32x32x16_bf16 v[16:31], v[112:115], v[96:99], 0
  ds_read_b128 v[128:131], v146 offset:37632
  v_exp_f32 v32, v32
  ds_read_b128 v[132:135], v146 offset:38304
  v_exp_f32 v33, v33
  v_exp_f32 v34, v34
  v_exp_f32 v35, v35
  v_mfma_f32_32x32x16_bf16 v[16:31], v[116:119], v[100:103], v[16:31]
  v_exp_f32 v36, v36
  v_exp_f32 v37, v37
  v_cvt_pk_bf16_f32 v88, v32, v33
  v_exp_f32 v38, v38
  v_cvt_pk_bf16_f32 v89, v34, v35
  v_exp_f32 v39, v39
  v_mfma_f32_32x32x16_bf16 v[48:63], v[136:139], v[80:83], v[48:63]
  v_exp_f32 v40, v40
  v_exp_f32 v41, v41
  v_cvt_pk_bf16_f32 v90, v36, v37
  v_exp_f32 v42, v42
  v_cvt_pk_bf16_f32 v91, v38, v39
  v_exp_f32 v43, v43
  v_mfma_f32_32x32x16_bf16 v[48:63], v[140:143], v[84:87], v[48:63]
  v_exp_f32 v44, v44
  v_exp_f32 v45, v45
  v_cvt_pk_bf16_f32 v92, v40, v41
  v_exp_f32 v46, v46
  v_cvt_pk_bf16_f32 v93, v42, v43
  v_cvt_pk_bf16_f32 v94, v44, v45
  v_exp_f32 v47, v47
  s_waitcnt lgkmcnt(0)
  v_cvt_pk_bf16_f32 v95, v46, v47
  v_mfma_f32_32x32x16_bf16 v[32:47], v[112:115], v[104:107], 0
  ds_read_b128 v[120:123], v144 offset:40320
  v_exp_f32 v16, v16
  ds_read_b64 v[124:125], v145 offset:40320
  v_exp_f32 v17, v17
  v_exp_f32 v18, v18
  v_exp_f32 v19, v19
  v_mfma_f32_32x32x16_bf16 v[32:47], v[116:119], v[108:111], v[32:47]
  v_exp_f32 v20, v20
  v_exp_f32 v21, v21
  v_cvt_pk_bf16_f32 v80, v16, v17
  v_exp_f32 v22, v22
  v_cvt_pk_bf16_f32 v81, v18, v19
  v_exp_f32 v23, v23
  v_mfma_f32_32x32x16_bf16 v[64:79], v[136:139], v[88:91], v[64:79]
  v_exp_f32 v24, v24
  v_exp_f32 v25, v25
  v_cvt_pk_bf16_f32 v82, v20, v21
  v_exp_f32 v26, v26
  v_cvt_pk_bf16_f32 v83, v22, v23
  v_exp_f32 v27, v27
  v_mfma_f32_32x32x16_bf16 v[64:79], v[140:143], v[92:95], v[64:79]
  v_exp_f32 v28, v28
  v_exp_f32 v29, v29
  v_cvt_pk_bf16_f32 v84, v24, v25
  v_exp_f32 v30, v30
  v_cvt_pk_bf16_f32 v85, v26, v27
  v_cvt_pk_bf16_f32 v86, v28, v29
  v_exp_f32 v31, v31
  s_waitcnt lgkmcnt(0)
  v_cvt_pk_bf16_f32 v87, v30, v31
  v_mfma_f32_32x32x16_bf16 v[16:31], v[120:123], v[96:99], 0
  ds_read_b128 v[136:139], v146 offset:40320
  v_exp_f32 v32, v32
  ds_read_b128 v[140:143], v146 offset:40992
  v_exp_f32 v33, v33
  v_exp_f32 v34, v34
  v_exp_f32 v35, v35
  v_mfma_f32_32x32x16_bf16 v[16:31], v[124:127], v[100:103], v[16:31]
  v_exp_f32 v36, v36
  v_exp_f32 v37, v37
  v_cvt_pk_bf16_f32 v88, v32, v33
  v_exp_f32 v38, v38
  v_cvt_pk_bf16_f32 v89, v34, v35
  v_exp_f32 v39, v39
  v_mfma_f32_32x32x16_bf16 v[48:63], v[128:131], v[80:83], v[48:63]
  v_exp_f32 v40, v40
  v_exp_f32 v41, v41
  v_cvt_pk_bf16_f32 v90, v36, v37
  v_exp_f32 v42, v42
  v_cvt_pk_bf16_f32 v91, v38, v39
  v_exp_f32 v43, v43
  v_mfma_f32_32x32x16_bf16 v[48:63], v[132:135], v[84:87], v[48:63]
  v_exp_f32 v44, v44
  v_exp_f32 v45, v45
  v_cvt_pk_bf16_f32 v92, v40, v41
  v_exp_f32 v46, v46
  v_cvt_pk_bf16_f32 v93, v42, v43
  v_cvt_pk_bf16_f32 v94, v44, v45
  v_exp_f32 v47, v47
  s_waitcnt lgkmcnt(0)
  v_cvt_pk_bf16_f32 v95, v46, v47
  s_barrier
  v_mfma_f32_32x32x16_bf16 v[32:47], v[120:123], v[104:107], 0
  ds_read_b128 v[112:115], v144 offset:0
  v_exp_f32 v16, v16
  ds_read_b64 v[116:117], v145 offset:0
  v_exp_f32 v17, v17
  v_exp_f32 v18, v18
  v_exp_f32 v19, v19
  v_mfma_f32_32x32x16_bf16 v[32:47], v[124:127], v[108:111], v[32:47]
  v_exp_f32 v20, v20
  v_exp_f32 v21, v21
  v_cvt_pk_bf16_f32 v80, v16, v17
  v_exp_f32 v22, v22
  v_cvt_pk_bf16_f32 v81, v18, v19
  v_exp_f32 v23, v23
  v_mfma_f32_32x32x16_bf16 v[64:79], v[128:131], v[88:91], v[64:79]
  v_exp_f32 v24, v24
  v_exp_f32 v25, v25
  v_cvt_pk_bf16_f32 v82, v20, v21
  v_exp_f32 v26, v26
  v_cvt_pk_bf16_f32 v83, v22, v23
  v_exp_f32 v27, v27
  v_mfma_f32_32x32x16_bf16 v[64:79], v[132:135], v[92:95], v[64:79]
  v_exp_f32 v28, v28
  v_exp_f32 v29, v29
  v_cvt_pk_bf16_f32 v84, v24, v25
  v_exp_f32 v30, v30
  v_cvt_pk_bf16_f32 v85, v26, v27
  v_cvt_pk_bf16_f32 v86, v28, v29
  v_exp_f32 v31, v31
  s_waitcnt lgkmcnt(0)
  v_cvt_pk_bf16_f32 v87, v30, v31
  v_mfma_f32_32x32x16_bf16 v[16:31], v[112:115], v[96:99], 0
  ds_read_b128 v[128:131], v146 offset:0
  v_exp_f32 v32, v32
  ds_read_b128 v[132:135], v146 offset:672
  v_exp_f32 v33, v33
  v_exp_f32 v34, v34
  v_exp_f32 v35, v35
  v_mfma_f32_32x32x16_bf16 v[16:31], v[116:119], v[100:103], v[16:31]
  v_exp_f32 v36, v36
  v_exp_f32 v37, v37
  v_cvt_pk_bf16_f32 v88, v32, v33
  v_exp_f32 v38, v38
  v_cvt_pk_bf16_f32 v89, v34, v35
  v_exp_f32 v39, v39
  v_mfma_f32_32x32x16_bf16 v[48:63], v[136:139], v[80:83], v[48:63]
  v_exp_f32 v40, v40
  v_exp_f32 v41, v41
  v_cvt_pk_bf16_f32 v90, v36, v37
  v_exp_f32 v42, v42
  v_cvt_pk_bf16_f32 v91, v38, v39
  v_exp_f32 v43, v43
  v_mfma_f32_32x32x16_bf16 v[48:63], v[140:143], v[84:87], v[48:63]
  v_exp_f32 v44, v44
  v_exp_f32 v45, v45
  v_cvt_pk_bf16_f32 v92, v40, v41
  v_exp_f32 v46, v46
  v_cvt_pk_bf16_f32 v93, v42, v43
  v_cvt_pk_bf16_f32 v94, v44, v45
  v_exp_f32 v47, v47
  s_add_u32 s24, s24, 1
  v_cvt_pk_bf16_f32 v95, v46, v47
  s_cmp_lt_u32 s24, 4
  s_waitcnt lgkmcnt(0)
  s_cbranch_scc1 KF_LOOP
  ds_read_b64 v[10:11], v15 offset:32
  v_mfma_f32_32x32x16_bf16 v[64:79], v[136:139], v[88:91], v[64:79]
  v_mfma_f32_32x32x16_bf16 v[64:79], v[140:143], v[92:95], v[64:79]
  s_mov_b32 s26, 0x4e800000
  s_mov_b32 s27, 0x30800000
  v_cmp_nlt_f32 s[42:43], v60, s26
  v_cmp_ngt_f32 s[44:45], v60, s27
  s_waitcnt lgkmcnt(0)
  v_readfirstlane_b32 s28, v10
  v_readfirstlane_b32 s29, v11
  s_nop 4
  v_cmp_nlt_f32 s[46:47], v76, s26
  v_cmp_ngt_f32 s[76:77], v76, s27
  s_or_b64 s[42:43], s[42:43], s[44:45]
  s_or_b64 s[46:47], s[46:47], s[76:77]
  s_or_b64 s[42:43], s[42:43], s[46:47]
  s_cbranch_scc1 KF_FB
KF_STORE:
  v_rcp_f32 v12, v60
  s_nop 7
  v_rcp_f32 v13, v76
  s_lshl_b32 s42, s32, 2
  s_add_u32 s42, s42, s34
  s_mul_i32 s43, s42, 20480
  s_add_u32 s43, s43, 1048576
  s_lshl_b32 s44, s33, 11
  s_add_u32 s44, s44, s43
  s_lshl_b32 s45, s33, 9
  s_add_u32 s45, s45, s43
  s_add_u32 s45, s45, 16384
  s_lshl_b32 s42, s42, 7
  s_add_u32 s42, s42, 196608
  s_lshl_b32 s46, s33, 2
  s_add_u32 s46, s46, s42
  v_lshlrev_b32 v9, 4, v2
  v_lshl_add_u32 v10, v6, 30, v9
  v_mul_f32 v48, v48, v12
  v_mul_f32 v49, v49, v12
  v_mul_f32 v50, v50, v12
  v_mul_f32 v51, v51, v12
  v_mul_f32 v52, v52, v12
  v_mul_f32 v53, v53, v12
  v_mul_f32 v54, v54, v12
  v_mul_f32 v55, v55, v12
  v_mul_f32 v56, v56, v12
  v_mul_f32 v57, v57, v12
  v_mul_f32 v58, v58, v12
  v_mul_f32 v59, v59, v12
  v_cvt_pk_bf16_f32 v136, v48, v49
  v_cvt_pk_bf16_f32 v137, v50, v51
  v_cvt_pk_bf16_f32 v138, v52, v53
  v_cvt_pk_bf16_f32 v139, v54, v55
  v_cvt_pk_bf16_f32 v144, v56, v57
  v_cvt_pk_bf16_f32 v145, v58, v59
  v_mul_f32 v64, v64, v13
  v_mul_f32 v65, v65, v13
  v_mul_f32 v66, v66, v13
  v_mul_f32 v67, v67, v13
  v_mul_f32 v68, v68, v13
  v_mul_f32 v69, v69, v13
  v_mul_f32 v70, v70, v13
  v_mul_f32 v71, v71, v13
  v_mul_f32 v72, v72, v13
  v_mul_f32 v73, v73, v13
  v_mul_f32 v74, v74, v13
  v_mul_f32 v75, v75, v13
  v_cvt_pk_bf16_f32 v140, v64, v65
  v_cvt_pk_bf16_f32 v141, v66, v67
  v_cvt_pk_bf16_f32 v142, v68, v69
  v_cvt_pk_bf16_f32 v143, v70, v71
  v_cvt_pk_bf16_f32 v146, v72, v73
  v_cvt_pk_bf16_f32 v147, v74, v75
  v_lshrrev_b32 v11, 2, v2
  v_mul_u32_u24 v11, 160, v11
  v_and_b32 v13, 3, v2
  v_lshl_add_u32 v11, v13, 3, v11
  v_mov_b32 v13, 0
  v_mov_b32 v14, 1
  s_cmp_eq_u32 s28, 1
  s_cbranch_scc1 KF_FAST
  buffer_store_dwordx4 v[136:139], v9, s[8:11], s44 offen sc1
  buffer_store_dwordx4 v[140:143], v9, s[8:11], s44 offen offset:1024 sc1
  buffer_store_dwordx4 v[144:147], v10, s[8:11], s45 offen sc1
  ds_read_b64_tr_b16 v[36:37], v11 offset:0
  ds_read_b64_tr_b16 v[38:39], v11 offset:2560
  ds_read_b64_tr_b16 v[40:41], v11 offset:32
  ds_read_b64_tr_b16 v[42:43], v11 offset:2592
  ds_read_b64_tr_b16 v[44:45], v11 offset:64
  ds_read_b64_tr_b16 v[46:47], v11 offset:2624
  ds_read_b64_tr_b16 v[48:49], v11 offset:96
  ds_read_b64_tr_b16 v[50:51], v11 offset:2656
  ds_read_b64_tr_b16 v[52:53], v11 offset:128
  ds_read_b64_tr_b16 v[54:55], v11 offset:2688
  s_waitcnt vmcnt(0)
  s_mov_b64 exec, 1
  buffer_store_dword v14, v13, s[8:11], s46 offen sc1
  s_mov_b64 exec, -1
  s_branch KF_P3
KF_FAST:
  buffer_store_dwordx4 v[136:139], v9, s[8:11], s44 offen
  buffer_store_dwordx4 v[140:143], v9, s[8:11], s44 offen offset:1024
  buffer_store_dwordx4 v[144:147], v10, s[8:11], s45 offen
  ds_read_b64_tr_b16 v[36:37], v11 offset:0
  ds_read_b64_tr_b16 v[38:39], v11 offset:2560
  ds_read_b64_tr_b16 v[40:41], v11 offset:32
  ds_read_b64_tr_b16 v[42:43], v11 offset:2592
  ds_read_b64_tr_b16 v[44:45], v11 offset:64
  ds_read_b64_tr_b16 v[46:47], v11 offset:2624
  ds_read_b64_tr_b16 v[48:49], v11 offset:96
  ds_read_b64_tr_b16 v[50:51], v11 offset:2656
  ds_read_b64_tr_b16 v[52:53], v11 offset:128
  ds_read_b64_tr_b16 v[54:55], v11 offset:2688
  s_waitcnt vmcnt(0)
  s_mov_b64 exec, 1
  buffer_store_dword v14, v13, s[8:11], s46 offen
  s_mov_b64 exec, -1
KF_P3:
  v_and_b32 v12, 7, v2
  v_lshlrev_b32 v12, 2, v12
  s_mov_b32 s47, 131072
  buffer_load_dword v13, v12, s[8:11], s42 offen sc1
  s_waitcnt lgkmcnt(5)
  ds_read_b64_tr_b16 v[56:57], v11 offset:5120
  ds_read_b64_tr_b16 v[58:59], v11 offset:7680
  ds_read_b64_tr_b16 v[60:61], v11 offset:5152
  ds_read_b64_tr_b16 v[62:63], v11 offset:7712
  ds_read_b64_tr_b16 v[64:65], v11 offset:5184
  ds_read_b64_tr_b16 v[66:67], v11 offset:7744
  ds_read_b64_tr_b16 v[68:69], v11 offset:5216
  ds_read_b64_tr_b16 v[70:71], v11 offset:7776
  ds_read_b64_tr_b16 v[72:73], v11 offset:5248
  ds_read_b64_tr_b16 v[74:75], v11 offset:7808
  v_and_b32 v117, 0xffff0000, v152
  v_lshlrev_b32 v116, 16, v152
  v_and_b32 v119, 0xffff0000, v153
  v_lshlrev_b32 v118, 16, v153
  v_and_b32 v121, 0xffff0000, v154
  v_lshlrev_b32 v120, 16, v154
  v_and_b32 v123, 0xffff0000, v155
  v_lshlrev_b32 v122, 16, v155
  v_and_b32 v125, 0xffff0000, v156
  v_lshlrev_b32 v124, 16, v156
  v_and_b32 v127, 0xffff0000, v157
  v_lshlrev_b32 v126, 16, v157
  v_and_b32 v129, 0xffff0000, v158
  v_lshlrev_b32 v128, 16, v158
  v_and_b32 v131, 0xffff0000, v159
  v_lshlrev_b32 v130, 16, v159
  v_and_b32 v133, 0xffff0000, v160
  v_lshlrev_b32 v132, 16, v160
  v_and_b32 v135, 0xffff0000, v161
  v_lshlrev_b32 v134, 16, v161
  s_waitcnt lgkmcnt(5)
  ds_read_b64_tr_b16 v[76:77], v11 offset:10240
  ds_read_b64_tr_b16 v[78:79], v11 offset:12800
  ds_read_b64_tr_b16 v[80:81], v11 offset:10272
  ds_read_b64_tr_b16 v[82:83], v11 offset:12832
  ds_read_b64_tr_b16 v[84:85], v11 offset:10304
  ds_read_b64_tr_b16 v[86:87], v11 offset:12864
  ds_read_b64_tr_b16 v[88:89], v11 offset:10336
  ds_read_b64_tr_b16 v[90:91], v11 offset:12896
  ds_read_b64_tr_b16 v[92:93], v11 offset:10368
  ds_read_b64_tr_b16 v[94:95], v11 offset:12928
  v_mov_b32 v16, 0xbfb8aa3b
  v_mov_b32 v17, 1.0
  v_pk_add_f32 v[18:19], v[116:117], v[148:149] op_sel_hi:[1,0] neg_lo:[0,1] neg_hi:[0,1]
  v_cvt_pk_bf16_f32 v18, v18, v19
  v_and_b32 v19, 0xffff0000, v18
  v_lshlrev_b32 v18, 16, v18
  v_pk_mul_f32 v[18:19], v[18:19], v[148:149] op_sel:[0,1] op_sel_hi:[1,1]
  v_cvt_pk_bf16_f32 v18, v18, v19
  v_and_b32 v19, 0xffff0000, v18
  v_lshlrev_b32 v18, 16, v18
  v_pk_mul_f32 v[20:21], v[18:19], v[16:17] op_sel_hi:[1,0]
  v_exp_f32 v20, v20
  v_exp_f32 v21, v21
  s_nop 0
  v_pk_add_f32 v[20:21], v[20:21], v[16:17] op_sel:[0,1] op_sel_hi:[1,1]
  v_rcp_f32 v20, v20
  v_rcp_f32 v21, v21
  s_nop 0
  v_pk_mul_f32 v[18:19], v[18:19], v[20:21]
  v_cvt_pk_bf16_f32 v162, v18, v19
  v_pk_add_f32 v[22:23], v[118:119], v[148:149] op_sel_hi:[1,0] neg_lo:[0,1] neg_hi:[0,1]
  v_cvt_pk_bf16_f32 v22, v22, v23
  v_and_b32 v23, 0xffff0000, v22
  v_lshlrev_b32 v22, 16, v22
  v_pk_mul_f32 v[22:23], v[22:23], v[148:149] op_sel:[0,1] op_sel_hi:[1,1]
  v_cvt_pk_bf16_f32 v22, v22, v23
  v_and_b32 v23, 0xffff0000, v22
  v_lshlrev_b32 v22, 16, v22
  v_pk_mul_f32 v[24:25], v[22:23], v[16:17] op_sel_hi:[1,0]
  v_exp_f32 v24, v24
  v_exp_f32 v25, v25
  s_nop 0
  v_pk_add_f32 v[24:25], v[24:25], v[16:17] op_sel:[0,1] op_sel_hi:[1,1]
  v_rcp_f32 v24, v24
  v_rcp_f32 v25, v25
  s_nop 0
  v_pk_mul_f32 v[22:23], v[22:23], v[24:25]
  v_cvt_pk_bf16_f32 v163, v22, v23
  v_pk_add_f32 v[18:19], v[120:121], v[148:149] op_sel_hi:[1,0] neg_lo:[0,1] neg_hi:[0,1]
  v_cvt_pk_bf16_f32 v18, v18, v19
  v_and_b32 v19, 0xffff0000, v18
  v_lshlrev_b32 v18, 16, v18
  v_pk_mul_f32 v[18:19], v[18:19], v[148:149] op_sel:[0,1] op_sel_hi:[1,1]
  v_cvt_pk_bf16_f32 v18, v18, v19
  v_and_b32 v19, 0xffff0000, v18
  v_lshlrev_b32 v18, 16, v18
  v_pk_mul_f32 v[20:21], v[18:19], v[16:17] op_sel_hi:[1,0]
  v_exp_f32 v20, v20
  v_exp_f32 v21, v21
  s_nop 0
  v_pk_add_f32 v[20:21], v[20:21], v[16:17] op_sel:[0,1] op_sel_hi:[1,1]
  v_rcp_f32 v20, v20
  v_rcp_f32 v21, v21
  s_nop 0
  v_pk_mul_f32 v[18:19], v[18:19], v[20:21]
  v_cvt_pk_bf16_f32 v164, v18, v19
  v_pk_add_f32 v[22:23], v[122:123], v[148:149] op_sel_hi:[1,0] neg_lo:[0,1] neg_hi:[0,1]
  v_cvt_pk_bf16_f32 v22, v22, v23
  v_and_b32 v23, 0xffff0000, v22
  v_lshlrev_b32 v22, 16, v22
  v_pk_mul_f32 v[22:23], v[22:23], v[148:149] op_sel:[0,1] op_sel_hi:[1,1]
  v_cvt_pk_bf16_f32 v22, v22, v23
  v_and_b32 v23, 0xffff0000, v22
  v_lshlrev_b32 v22, 16, v22
  v_pk_mul_f32 v[24:25], v[22:23], v[16:17] op_sel_hi:[1,0]
  v_exp_f32 v24, v24
  v_exp_f32 v25, v25
  s_nop 0
  v_pk_add_f32 v[24:25], v[24:25], v[16:17] op_sel:[0,1] op_sel_hi:[1,1]
  v_rcp_f32 v24, v24
  v_rcp_f32 v25, v25
  s_nop 0
  v_pk_mul_f32 v[22:23], v[22:23], v[24:25]
  v_cvt_pk_bf16_f32 v165, v22, v23
  v_pk_add_f32 v[18:19], v[124:125], v[148:149] op_sel_hi:[1,0] neg_lo:[0,1] neg_hi:[0,1]
  v_cvt_pk_bf16_f32 v18, v18, v19
  v_and_b32 v19, 0xffff0000, v18
  v_lshlrev_b32 v18, 16, v18
  v_pk_mul_f32 v[18:19], v[18:19], v[148:149] op_sel:[0,1] op_sel_hi:[1,1]
  v_cvt_pk_bf16_f32 v18, v18, v19
  v_and_b32 v19, 0xffff0000, v18
  v_lshlrev_b32 v18, 16, v18
  v_pk_mul_f32 v[20:21], v[18:19], v[16:17] op_sel_hi:[1,0]
  v_exp_f32 v20, v20
  v_exp_f32 v21, v21
  s_nop 0
  v_pk_add_f32 v[20:21], v[20:21], v[16:17] op_sel:[0,1] op_sel_hi:[1,1]
  v_rcp_f32 v20, v20
  v_rcp_f32 v21, v21
  s_nop 0
  v_pk_mul_f32 v[18:19], v[18:19], v[20:21]
  v_cvt_pk_bf16_f32 v166, v18, v19
  v_pk_add_f32 v[22:23], v[126:127], v[148:149] op_sel_hi:[1,0] neg_lo:[0,1] neg_hi:[0,1]
  v_cvt_pk_bf16_f32 v22, v22, v23
  v_and_b32 v23, 0xffff0000, v22
  v_lshlrev_b32 v22, 16, v22
  v_pk_mul_f32 v[22:23], v[22:23], v[148:149] op_sel:[0,1] op_sel_hi:[1,1]
  v_cvt_pk_bf16_f32 v22, v22, v23
  v_and_b32 v23, 0xffff0000, v22
  v_lshlrev_b32 v22, 16, v22
  v_pk_mul_f32 v[24:25], v[22:23], v[16:17] op_sel_hi:[1,0]
  v_exp_f32 v24, v24
  v_exp_f32 v25, v25
  s_nop 0
  v_pk_add_f32 v[24:25], v[24:25], v[16:17] op_sel:[0,1] op_sel_hi:[1,1]
  v_rcp_f32 v24, v24
  v_rcp_f32 v25, v25
  s_nop 0
  v_pk_mul_f32 v[22:23], v[22:23], v[24:25]
  v_cvt_pk_bf16_f32 v167, v22, v23
  v_pk_add_f32 v[18:19], v[128:129], v[148:149] op_sel_hi:[1,0] neg_lo:[0,1] neg_hi:[0,1]
  v_cvt_pk_bf16_f32 v18, v18, v19
  v_and_b32 v19, 0xffff0000, v18
  v_lshlrev_b32 v18, 16, v18
  v_pk_mul_f32 v[18:19], v[18:19], v[148:149] op_sel:[0,1] op_sel_hi:[1,1]
  v_cvt_pk_bf16_f32 v18, v18, v19
  v_and_b32 v19, 0xffff0000, v18
  v_lshlrev_b32 v18, 16, v18
  v_pk_mul_f32 v[20:21], v[18:19], v[16:17] op_sel_hi:[1,0]
  v_exp_f32 v20, v20
  v_exp_f32 v21, v21
  s_nop 0
  v_pk_add_f32 v[20:21], v[20:21], v[16:17] op_sel:[0,1] op_sel_hi:[1,1]
  v_rcp_f32 v20, v20
  v_rcp_f32 v21, v21
  s_nop 0
  v_pk_mul_f32 v[18:19], v[18:19], v[20:21]
  v_cvt_pk_bf16_f32 v168, v18, v19
  v_pk_add_f32 v[22:23], v[130:131], v[148:149] op_sel_hi:[1,0] neg_lo:[0,1] neg_hi:[0,1]
  v_cvt_pk_bf16_f32 v22, v22, v23
  v_and_b32 v23, 0xffff0000, v22
  v_lshlrev_b32 v22, 16, v22
  v_pk_mul_f32 v[22:23], v[22:23], v[148:149] op_sel:[0,1] op_sel_hi:[1,1]
  v_cvt_pk_bf16_f32 v22, v22, v23
  v_and_b32 v23, 0xffff0000, v22
  v_lshlrev_b32 v22, 16, v22
  v_pk_mul_f32 v[24:25], v[22:23], v[16:17] op_sel_hi:[1,0]
  v_exp_f32 v24, v24
  v_exp_f32 v25, v25
  s_nop 0
  v_pk_add_f32 v[24:25], v[24:25], v[16:17] op_sel:[0,1] op_sel_hi:[1,1]
  v_rcp_f32 v24, v24
  v_rcp_f32 v25, v25
  s_nop 0
  v_pk_mul_f32 v[22:23], v[22:23], v[24:25]
  v_cvt_pk_bf16_f32 v169, v22, v23
  v_pk_add_f32 v[18:19], v[132:133], v[148:149] op_sel_hi:[1,0] neg_lo:[0,1] neg_hi:[0,1]
  v_cvt_pk_bf16_f32 v18, v18, v19
  v_and_b32 v19, 0xffff0000, v18
  v_lshlrev_b32 v18, 16, v18
  v_pk_mul_f32 v[18:19], v[18:19], v[148:149] op_sel:[0,1] op_sel_hi:[1,1]
  v_cvt_pk_bf16_f32 v18, v18, v19
  v_and_b32 v19, 0xffff0000, v18
  v_lshlrev_b32 v18, 16, v18
  v_pk_mul_f32 v[20:21], v[18:19], v[16:17] op_sel_hi:[1,0]
  v_exp_f32 v20, v20
  v_exp_f32 v21, v21
  s_nop 0
  v_pk_add_f32 v[20:21], v[20:21], v[16:17] op_sel:[0,1] op_sel_hi:[1,1]
  v_rcp_f32 v20, v20
  v_rcp_f32 v21, v21
  s_nop 0
  v_pk_mul_f32 v[18:19], v[18:19], v[20:21]
  v_cvt_pk_bf16_f32 v170, v18, v19
  v_pk_add_f32 v[22:23], v[134:135], v[148:149] op_sel_hi:[1,0] neg_lo:[0,1] neg_hi:[0,1]
  v_cvt_pk_bf16_f32 v22, v22, v23
  v_and_b32 v23, 0xffff0000, v22
  v_lshlrev_b32 v22, 16, v22
  v_pk_mul_f32 v[22:23], v[22:23], v[148:149] op_sel:[0,1] op_sel_hi:[1,1]
  v_cvt_pk_bf16_f32 v22, v22, v23
  v_and_b32 v23, 0xffff0000, v22
  v_lshlrev_b32 v22, 16, v22
  v_pk_mul_f32 v[24:25], v[22:23], v[16:17] op_sel_hi:[1,0]
  v_exp_f32 v24, v24
  v_exp_f32 v25, v25
  s_nop 0
  v_pk_add_f32 v[24:25], v[24:25], v[16:17] op_sel:[0,1] op_sel_hi:[1,1]
  v_rcp_f32 v24, v24
  v_rcp_f32 v25, v25
  s_nop 0
  v_pk_mul_f32 v[22:23], v[22:23], v[24:25]
  v_cvt_pk_bf16_f32 v171, v22, v23
  s_lshr_b32 s44, s29, 4
  s_lshl_b32 s45, s32, 2
  s_add_u32 s45, s45, s34
  s_cmp_eq_u32 s44, s45
  s_cbranch_scc0 KF_NSP
  v_lshlrev_b32 v14, 3, v3
  v_add_u32 v14, 159104, v14
  s_and_b32 s44, s29, 15
  v_cmp_eq_u32 vcc, s44, v4
  s_waitcnt lgkmcnt(0)
  ds_read_b64 v[136:137], v14 offset:0
  ds_read_b64 v[138:139], v14 offset:32
  ds_read_b64 v[140:141], v14 offset:64
  ds_read_b64 v[142:143], v14 offset:96
  ds_read_b64 v[144:145], v14 offset:128
  s_waitcnt lgkmcnt(0)
  v_cndmask_b32 v162, v162, v136, vcc
  v_cndmask_b32 v163, v163, v137, vcc
  v_cndmask_b32 v164, v164, v138, vcc
  v_cndmask_b32 v165, v165, v139, vcc
  v_cndmask_b32 v166, v166, v140, vcc
  v_cndmask_b32 v167, v167, v141, vcc
  v_cndmask_b32 v168, v168, v142, vcc
  v_cndmask_b32 v169, v169, v143, vcc
  v_cndmask_b32 v170, v170, v144, vcc
  v_cndmask_b32 v171, v171, v145, vcc
KF_NSP:
  s_waitcnt lgkmcnt(5)
  ds_read_b64_tr_b16 v[96:97], v11 offset:15360
  ds_read_b64_tr_b16 v[98:99], v11 offset:17920
  ds_read_b64_tr_b16 v[100:101], v11 offset:15392
  ds_read_b64_tr_b16 v[102:103], v11 offset:17952
  ds_read_b64_tr_b16 v[104:105], v11 offset:15424
  ds_read_b64_tr_b16 v[106:107], v11 offset:17984
  ds_read_b64_tr_b16 v[108:109], v11 offset:15456
  ds_read_b64_tr_b16 v[110:111], v11 offset:18016
  ds_read_b64_tr_b16 v[112:113], v11 offset:15488
  ds_read_b64_tr_b16 v[114:115], v11 offset:18048
  v_and_b32 v137, 0xffff0000, v162
  v_lshlrev_b32 v136, 16, v162
  v_and_b32 v139, 0xffff0000, v163
  v_lshlrev_b32 v138, 16, v163
  v_and_b32 v141, 0xffff0000, v164
  v_lshlrev_b32 v140, 16, v164
  v_and_b32 v143, 0xffff0000, v165
  v_lshlrev_b32 v142, 16, v165
  v_and_b32 v145, 0xffff0000, v166
  v_lshlrev_b32 v144, 16, v166
  v_and_b32 v147, 0xffff0000, v167
  v_lshlrev_b32 v146, 16, v167
  v_and_b32 v149, 0xffff0000, v168
  v_lshlrev_b32 v148, 16, v168
  v_and_b32 v151, 0xffff0000, v169
  v_lshlrev_b32 v150, 16, v169
  v_and_b32 v153, 0xffff0000, v170
  v_lshlrev_b32 v152, 16, v170
  v_and_b32 v155, 0xffff0000, v171
  v_lshlrev_b32 v154, 16, v171
KF_POLL3:
  s_waitcnt vmcnt(0)
  v_cmp_ne_u32 vcc, 0, v13
  s_sub_u32 s47, s47, 1
  s_cbranch_scc1 KF_GO3
  s_cmp_eq_u64 vcc, -1
  s_cbranch_scc1 KF_GO3
  buffer_load_dword v13, v12, s[8:11], s42 offen sc1
  s_branch KF_POLL3
KF_GO3:
  buffer_load_dwordx4 v[172:175], v9, s[8:11], s43 offen offset:0
  buffer_load_dwordx4 v[176:179], v9, s[8:11], s43 offen offset:1024
  buffer_load_dwordx4 v[180:183], v9, s[8:11], s43 offen offset:2048
  buffer_load_dwordx4 v[184:187], v9, s[8:11], s43 offen offset:3072
  s_add_u32 s43, s43, 4096
  buffer_load_dwordx4 v[188:191], v9, s[8:11], s43 offen offset:0
  buffer_load_dwordx4 v[192:195], v9, s[8:11], s43 offen offset:1024
  buffer_load_dwordx4 v[196:199], v9, s[8:11], s43 offen offset:2048
  buffer_load_dwordx4 v[200:203], v9, s[8:11], s43 offen offset:3072
  s_add_u32 s43, s43, 4096
  buffer_load_dwordx4 v[204:207], v9, s[8:11], s43 offen offset:0
  buffer_load_dwordx4 v[208:211], v9, s[8:11], s43 offen offset:1024
  buffer_load_dwordx4 v[212:215], v9, s[8:11], s43 offen offset:2048
  buffer_load_dwordx4 v[216:219], v9, s[8:11], s43 offen offset:3072
  s_add_u32 s43, s43, 4096
  buffer_load_dwordx4 v[220:223], v9, s[8:11], s43 offen offset:0
  buffer_load_dwordx4 v[224:227], v9, s[8:11], s43 offen offset:1024
  buffer_load_dwordx4 v[228:231], v9, s[8:11], s43 offen offset:2048
  buffer_load_dwordx4 v[232:235], v9, s[8:11], s43 offen offset:3072
  s_add_u32 s43, s43, 4096
  buffer_load_dwordx4 v[236:239], v9, s[8:11], s43 offen offset:0
  buffer_load_dwordx4 v[240:243], v9, s[8:11], s43 offen offset:1024
  buffer_load_dwordx4 v[244:247], v9, s[8:11], s43 offen offset:2048
  buffer_load_dwordx4 v[248:251], v9, s[8:11], s43 offen offset:3072
  s_waitcnt vmcnt(19) lgkmcnt(0)
  v_mfma_f32_16x16x32_bf16 v[16:19], v[36:39], v[172:175], 0
  v_mfma_f32_16x16x32_bf16 v[20:23], v[40:43], v[172:175], 0
  v_mfma_f32_16x16x32_bf16 v[24:27], v[44:47], v[172:175], 0
  v_mfma_f32_16x16x32_bf16 v[28:31], v[48:51], v[172:175], 0
  v_mfma_f32_16x16x32_bf16 v[32:35], v[52:55], v[172:175], 0
  ds_read_b64_tr_b16 v[36:37], v11 offset:20480
  ds_read_b64_tr_b16 v[38:39], v11 offset:23040
  ds_read_b64_tr_b16 v[40:41], v11 offset:20512
  ds_read_b64_tr_b16 v[42:43], v11 offset:23072
  ds_read_b64_tr_b16 v[44:45], v11 offset:20544
  ds_read_b64_tr_b16 v[46:47], v11 offset:23104
  ds_read_b64_tr_b16 v[48:49], v11 offset:20576
  ds_read_b64_tr_b16 v[50:51], v11 offset:23136
  ds_read_b64_tr_b16 v[52:53], v11 offset:20608
  ds_read_b64_tr_b16 v[54:55], v11 offset:23168
  s_waitcnt vmcnt(18) lgkmcnt(5)
  v_mfma_f32_16x16x32_bf16 v[16:19], v[56:59], v[176:179], v[16:19]
  v_mfma_f32_16x16x32_bf16 v[20:23], v[60:63], v[176:179], v[20:23]
  v_mfma_f32_16x16x32_bf16 v[24:27], v[64:67], v[176:179], v[24:27]
  v_mfma_f32_16x16x32_bf16 v[28:31], v[68:71], v[176:179], v[28:31]
  v_mfma_f32_16x16x32_bf16 v[32:35], v[72:75], v[176:179], v[32:35]
  ds_read_b64_tr_b16 v[56:57], v11 offset:25600
  ds_read_b64_tr_b16 v[58:59], v11 offset:28160
  ds_read_b64_tr_b16 v[60:61], v11 offset:25632
  ds_read_b64_tr_b16 v[62:63], v11 offset:28192
  ds_read_b64_tr_b16 v[64:65], v11 offset:25664
  ds_read_b64_tr_b16 v[66:67], v11 offset:28224
  ds_read_b64_tr_b16 v[68:69], v11 offset:25696
  ds_read_b64_tr_b16 v[70:71], v11 offset:28256
  ds_read_b64_tr_b16 v[72:73], v11 offset:25728
  ds_read_b64_tr_b16 v[74:75], v11 offset:28288
  s_waitcnt vmcnt(17) lgkmcnt(5)
  v_mfma_f32_16x16x32_bf16 v[16:19], v[76:79], v[180:183], v[16:19]
  v_mfma_f32_16x16x32_bf16 v[20:23], v[80:83], v[180:183], v[20:23]
  v_mfma_f32_16x16x32_bf16 v[24:27], v[84:87], v[180:183], v[24:27]
  v_mfma_f32_16x16x32_bf16 v[28:31], v[88:91], v[180:183], v[28:31]
  v_mfma_f32_16x16x32_bf16 v[32:35], v[92:95], v[180:183], v[32:35]
  ds_read_b64_tr_b16 v[76:77], v11 offset:30720
  ds_read_b64_tr_b16 v[78:79], v11 offset:33280
  ds_read_b64_tr_b16 v[80:81], v11 offset:30752
  ds_read_b64_tr_b16 v[82:83], v11 offset:33312
  ds_read_b64_tr_b16 v[84:85], v11 offset:30784
  ds_read_b64_tr_b16 v[86:87], v11 offset:33344
  ds_read_b64_tr_b16 v[88:89], v11 offset:30816
  ds_read_b64_tr_b16 v[90:91], v11 offset:33376
  ds_read_b64_tr_b16 v[92:93], v11 offset:30848
  ds_read_b64_tr_b16 v[94:95], v11 offset:33408
  s_waitcnt vmcnt(16) lgkmcnt(5)
  v_mfma_f32_16x16x32_bf16 v[16:19], v[96:99], v[184:187], v[16:19]
  v_mfma_f32_16x16x32_bf16 v[20:23], v[100:103], v[184:187], v[20:23]
  v_mfma_f32_16x16x32_bf16 v[24:27], v[104:107], v[184:187], v[24:27]
  v_mfma_f32_16x16x32_bf16 v[28:31], v[108:111], v[184:187], v[28:31]
  v_mfma_f32_16x16x32_bf16 v[32:35], v[112:115], v[184:187], v[32:35]
  ds_read_b64_tr_b16 v[96:97], v11 offset:35840
  ds_read_b64_tr_b16 v[98:99], v11 offset:38400
  ds_read_b64_tr_b16 v[100:101], v11 offset:35872
  ds_read_b64_tr_b16 v[102:103], v11 offset:38432
  ds_read_b64_tr_b16 v[104:105], v11 offset:35904
  ds_read_b64_tr_b16 v[106:107], v11 offset:38464
  ds_read_b64_tr_b16 v[108:109], v11 offset:35936
  ds_read_b64_tr_b16 v[110:111], v11 offset:38496
  ds_read_b64_tr_b16 v[112:113], v11 offset:35968
  ds_read_b64_tr_b16 v[114:115], v11 offset:38528
  s_waitcnt vmcnt(15) lgkmcnt(5)
  v_mfma_f32_16x16x32_bf16 v[16:19], v[36:39], v[188:191], v[16:19]
  v_mfma_f32_16x16x32_bf16 v[20:23], v[40:43], v[188:191], v[20:23]
  v_mfma_f32_16x16x32_bf16 v[24:27], v[44:47], v[188:191], v[24:27]
  v_mfma_f32_16x16x32_bf16 v[28:31], v[48:51], v[188:191], v[28:31]
  v_mfma_f32_16x16x32_bf16 v[32:35], v[52:55], v[188:191], v[32:35]
  ds_read_b64_tr_b16 v[36:37], v11 offset:40960
  ds_read_b64_tr_b16 v[38:39], v11 offset:43520
  ds_read_b64_tr_b16 v[40:41], v11 offset:40992
  ds_read_b64_tr_b16 v[42:43], v11 offset:43552
  ds_read_b64_tr_b16 v[44:45], v11 offset:41024
  ds_read_b64_tr_b16 v[46:47], v11 offset:43584
  ds_read_b64_tr_b16 v[48:49], v11 offset:41056
  ds_read_b64_tr_b16 v[50:51], v11 offset:43616
  ds_read_b64_tr_b16 v[52:53], v11 offset:41088
  ds_read_b64_tr_b16 v[54:55], v11 offset:43648
  s_waitcnt vmcnt(14) lgkmcnt(5)
  v_mfma_f32_16x16x32_bf16 v[16:19], v[56:59], v[192:195], v[16:19]
  v_mfma_f32_16x16x32_bf16 v[20:23], v[60:63], v[192:195], v[20:23]
  v_mfma_f32_16x16x32_bf16 v[24:27], v[64:67], v[192:195], v[24:27]
  v_mfma_f32_16x16x32_bf16 v[28:31], v[68:71], v[192:195], v[28:31]
  v_mfma_f32_16x16x32_bf16 v[32:35], v[72:75], v[192:195], v[32:35]
  ds_read_b64_tr_b16 v[56:57], v11 offset:46080
  ds_read_b64_tr_b16 v[58:59], v11 offset:48640
  ds_read_b64_tr_b16 v[60:61], v11 offset:46112
  ds_read_b64_tr_b16 v[62:63], v11 offset:48672
  ds_read_b64_tr_b16 v[64:65], v11 offset:46144
  ds_read_b64_tr_b16 v[66:67], v11 offset:48704
  ds_read_b64_tr_b16 v[68:69], v11 offset:46176
  ds_read_b64_tr_b16 v[70:71], v11 offset:48736
  ds_read_b64_tr_b16 v[72:73], v11 offset:46208
  ds_read_b64_tr_b16 v[74:75], v11 offset:48768
  s_waitcnt vmcnt(13) lgkmcnt(5)
  v_mfma_f32_16x16x32_bf16 v[16:19], v[76:79], v[196:199], v[16:19]
  v_mfma_f32_16x16x32_bf16 v[20:23], v[80:83], v[196:199], v[20:23]
  v_mfma_f32_16x16x32_bf16 v[24:27], v[84:87], v[196:199], v[24:27]
  v_mfma_f32_16x16x32_bf16 v[28:31], v[88:91], v[196:199], v[28:31]
  v_mfma_f32_16x16x32_bf16 v[32:35], v[92:95], v[196:199], v[32:35]
  v_add_u32 v11, 51200, v11
  ds_read_b64_tr_b16 v[76:77], v11 offset:0
  ds_read_b64_tr_b16 v[78:79], v11 offset:2560
  ds_read_b64_tr_b16 v[80:81], v11 offset:32
  ds_read_b64_tr_b16 v[82:83], v11 offset:2592
  ds_read_b64_tr_b16 v[84:85], v11 offset:64
  ds_read_b64_tr_b16 v[86:87], v11 offset:2624
  ds_read_b64_tr_b16 v[88:89], v11 offset:96
  ds_read_b64_tr_b16 v[90:91], v11 offset:2656
  ds_read_b64_tr_b16 v[92:93], v11 offset:128
  ds_read_b64_tr_b16 v[94:95], v11 offset:2688
  s_waitcnt vmcnt(12) lgkmcnt(5)
  v_mfma_f32_16x16x32_bf16 v[16:19], v[96:99], v[200:203], v[16:19]
  v_mfma_f32_16x16x32_bf16 v[20:23], v[100:103], v[200:203], v[20:23]
  v_mfma_f32_16x16x32_bf16 v[24:27], v[104:107], v[200:203], v[24:27]
  v_mfma_f32_16x16x32_bf16 v[28:31], v[108:111], v[200:203], v[28:31]
  v_mfma_f32_16x16x32_bf16 v[32:35], v[112:115], v[200:203], v[32:35]
  ds_read_b64_tr_b16 v[96:97], v11 offset:5120
  ds_read_b64_tr_b16 v[98:99], v11 offset:7680
  ds_read_b64_tr_b16 v[100:101], v11 offset:5152
  ds_read_b64_tr_b16 v[102:103], v11 offset:7712
  ds_read_b64_tr_b16 v[104:105], v11 offset:5184
  ds_read_b64_tr_b16 v[106:107], v11 offset:7744
  ds_read_b64_tr_b16 v[108:109], v11 offset:5216
  ds_read_b64_tr_b16 v[110:111], v11 offset:7776
  ds_read_b64_tr_b16 v[112:113], v11 offset:5248
  ds_read_b64_tr_b16 v[114:115], v11 offset:7808
  s_waitcnt vmcnt(11) lgkmcnt(5)
  v_mfma_f32_16x16x32_bf16 v[16:19], v[36:39], v[204:207], v[16:19]
  v_mfma_f32_16x16x32_bf16 v[20:23], v[40:43], v[204:207], v[20:23]
  v_mfma_f32_16x16x32_bf16 v[24:27], v[44:47], v[204:207], v[24:27]
  v_mfma_f32_16x16x32_bf16 v[28:31], v[48:51], v[204:207], v[28:31]
  v_mfma_f32_16x16x32_bf16 v[32:35], v[52:55], v[204:207], v[32:35]
  ds_read_b64_tr_b16 v[36:37], v11 offset:10240
  ds_read_b64_tr_b16 v[38:39], v11 offset:12800
  ds_read_b64_tr_b16 v[40:41], v11 offset:10272
  ds_read_b64_tr_b16 v[42:43], v11 offset:12832
  ds_read_b64_tr_b16 v[44:45], v11 offset:10304
  ds_read_b64_tr_b16 v[46:47], v11 offset:12864
  ds_read_b64_tr_b16 v[48:49], v11 offset:10336
  ds_read_b64_tr_b16 v[50:51], v11 offset:12896
  ds_read_b64_tr_b16 v[52:53], v11 offset:10368
  ds_read_b64_tr_b16 v[54:55], v11 offset:12928
  s_waitcnt vmcnt(10) lgkmcnt(5)
  v_mfma_f32_16x16x32_bf16 v[16:19], v[56:59], v[208:211], v[16:19]
  v_mfma_f32_16x16x32_bf16 v[20:23], v[60:63], v[208:211], v[20:23]
  v_mfma_f32_16x16x32_bf16 v[24:27], v[64:67], v[208:211], v[24:27]
  v_mfma_f32_16x16x32_bf16 v[28:31], v[68:71], v[208:211], v[28:31]
  v_mfma_f32_16x16x32_bf16 v[32:35], v[72:75], v[208:211], v[32:35]
  ds_read_b64_tr_b16 v[56:57], v11 offset:15360
  ds_read_b64_tr_b16 v[58:59], v11 offset:17920
  ds_read_b64_tr_b16 v[60:61], v11 offset:15392
  ds_read_b64_tr_b16 v[62:63], v11 offset:17952
  ds_read_b64_tr_b16 v[64:65], v11 offset:15424
  ds_read_b64_tr_b16 v[66:67], v11 offset:17984
  ds_read_b64_tr_b16 v[68:69], v11 offset:15456
  ds_read_b64_tr_b16 v[70:71], v11 offset:18016
  ds_read_b64_tr_b16 v[72:73], v11 offset:15488
  ds_read_b64_tr_b16 v[74:75], v11 offset:18048
  s_waitcnt vmcnt(9) lgkmcnt(5)
  v_mfma_f32_16x16x32_bf16 v[16:19], v[76:79], v[212:215], v[16:19]
  v_mfma_f32_16x16x32_bf16 v[20:23], v[80:83], v[212:215], v[20:23]
  v_mfma_f32_16x16x32_bf16 v[24:27], v[84:87], v[212:215], v[24:27]
  v_mfma_f32_16x16x32_bf16 v[28:31], v[88:91], v[212:215], v[28:31]
  v_mfma_f32_16x16x32_bf16 v[32:35], v[92:95], v[212:215], v[32:35]
  ds_read_b64_tr_b16 v[76:77], v11 offset:20480
  ds_read_b64_tr_b16 v[78:79], v11 offset:23040
  ds_read_b64_tr_b16 v[80:81], v11 offset:20512
  ds_read_b64_tr_b16 v[82:83], v11 offset:23072
  ds_read_b64_tr_b16 v[84:85], v11 offset:20544
  ds_read_b64_tr_b16 v[86:87], v11 offset:23104
  ds_read_b64_tr_b16 v[88:89], v11 offset:20576
  ds_read_b64_tr_b16 v[90:91], v11 offset:23136
  ds_read_b64_tr_b16 v[92:93], v11 offset:20608
  ds_read_b64_tr_b16 v[94:95], v11 offset:23168
  s_waitcnt vmcnt(8) lgkmcnt(5)
  v_mfma_f32_16x16x32_bf16 v[16:19], v[96:99], v[216:219], v[16:19]
  v_mfma_f32_16x16x32_bf16 v[20:23], v[100:103], v[216:219], v[20:23]
  v_mfma_f32_16x16x32_bf16 v[24:27], v[104:107], v[216:219], v[24:27]
  v_mfma_f32_16x16x32_bf16 v[28:31], v[108:111], v[216:219], v[28:31]
  v_mfma_f32_16x16x32_bf16 v[32:35], v[112:115], v[216:219], v[32:35]
  ds_read_b64_tr_b16 v[96:97], v11 offset:25600
  ds_read_b64_tr_b16 v[98:99], v11 offset:28160
  ds_read_b64_tr_b16 v[100:101], v11 offset:25632
  ds_read_b64_tr_b16 v[102:103], v11 offset:28192
  ds_read_b64_tr_b16 v[104:105], v11 offset:25664
  ds_read_b64_tr_b16 v[106:107], v11 offset:28224
  ds_read_b64_tr_b16 v[108:109], v11 offset:25696
  ds_read_b64_tr_b16 v[110:111], v11 offset:28256
  ds_read_b64_tr_b16 v[112:113], v11 offset:25728
  ds_read_b64_tr_b16 v[114:115], v11 offset:28288
  s_waitcnt vmcnt(7) lgkmcnt(5)
  v_mfma_f32_16x16x32_bf16 v[16:19], v[36:39], v[220:223], v[16:19]
  v_mfma_f32_16x16x32_bf16 v[20:23], v[40:43], v[220:223], v[20:23]
  v_mfma_f32_16x16x32_bf16 v[24:27], v[44:47], v[220:223], v[24:27]
  v_mfma_f32_16x16x32_bf16 v[28:31], v[48:51], v[220:223], v[28:31]
  v_mfma_f32_16x16x32_bf16 v[32:35], v[52:55], v[220:223], v[32:35]
  ds_read_b64_tr_b16 v[36:37], v11 offset:30720
  ds_read_b64_tr_b16 v[38:39], v11 offset:33280
  ds_read_b64_tr_b16 v[40:41], v11 offset:30752
  ds_read_b64_tr_b16 v[42:43], v11 offset:33312
  ds_read_b64_tr_b16 v[44:45], v11 offset:30784
  ds_read_b64_tr_b16 v[46:47], v11 offset:33344
  ds_read_b64_tr_b16 v[48:49], v11 offset:30816
  ds_read_b64_tr_b16 v[50:51], v11 offset:33376
  ds_read_b64_tr_b16 v[52:53], v11 offset:30848
  ds_read_b64_tr_b16 v[54:55], v11 offset:33408
  s_waitcnt vmcnt(6) lgkmcnt(5)
  v_mfma_f32_16x16x32_bf16 v[16:19], v[56:59], v[224:227], v[16:19]
  v_mfma_f32_16x16x32_bf16 v[20:23], v[60:63], v[224:227], v[20:23]
  v_mfma_f32_16x16x32_bf16 v[24:27], v[64:67], v[224:227], v[24:27]
  v_mfma_f32_16x16x32_bf16 v[28:31], v[68:71], v[224:227], v[28:31]
  v_mfma_f32_16x16x32_bf16 v[32:35], v[72:75], v[224:227], v[32:35]
  ds_read_b64_tr_b16 v[56:57], v11 offset:35840
  ds_read_b64_tr_b16 v[58:59], v11 offset:38400
  ds_read_b64_tr_b16 v[60:61], v11 offset:35872
  ds_read_b64_tr_b16 v[62:63], v11 offset:38432
  ds_read_b64_tr_b16 v[64:65], v11 offset:35904
  ds_read_b64_tr_b16 v[66:67], v11 offset:38464
  ds_read_b64_tr_b16 v[68:69], v11 offset:35936
  ds_read_b64_tr_b16 v[70:71], v11 offset:38496
  ds_read_b64_tr_b16 v[72:73], v11 offset:35968
  ds_read_b64_tr_b16 v[74:75], v11 offset:38528
  s_waitcnt vmcnt(5) lgkmcnt(5)
  v_mfma_f32_16x16x32_bf16 v[16:19], v[76:79], v[228:231], v[16:19]
  v_mfma_f32_16x16x32_bf16 v[20:23], v[80:83], v[228:231], v[20:23]
  v_mfma_f32_16x16x32_bf16 v[24:27], v[84:87], v[228:231], v[24:27]
  v_mfma_f32_16x16x32_bf16 v[28:31], v[88:91], v[228:231], v[28:31]
  v_mfma_f32_16x16x32_bf16 v[32:35], v[92:95], v[228:231], v[32:35]
  ds_read_b64_tr_b16 v[76:77], v11 offset:40960
  ds_read_b64_tr_b16 v[78:79], v11 offset:43520
  ds_read_b64_tr_b16 v[80:81], v11 offset:40992
  ds_read_b64_tr_b16 v[82:83], v11 offset:43552
  ds_read_b64_tr_b16 v[84:85], v11 offset:41024
  ds_read_b64_tr_b16 v[86:87], v11 offset:43584
  ds_read_b64_tr_b16 v[88:89], v11 offset:41056
  ds_read_b64_tr_b16 v[90:91], v11 offset:43616
  ds_read_b64_tr_b16 v[92:93], v11 offset:41088
  ds_read_b64_tr_b16 v[94:95], v11 offset:43648
  s_waitcnt vmcnt(4) lgkmcnt(5)
  v_mfma_f32_16x16x32_bf16 v[16:19], v[96:99], v[232:235], v[16:19]
  v_mfma_f32_16x16x32_bf16 v[20:23], v[100:103], v[232:235], v[20:23]
  v_mfma_f32_16x16x32_bf16 v[24:27], v[104:107], v[232:235], v[24:27]
  v_mfma_f32_16x16x32_bf16 v[28:31], v[108:111], v[232:235], v[28:31]
  v_mfma_f32_16x16x32_bf16 v[32:35], v[112:115], v[232:235], v[32:35]
  ds_read_b64_tr_b16 v[96:97], v11 offset:46080
  ds_read_b64_tr_b16 v[98:99], v11 offset:48640
  ds_read_b64_tr_b16 v[100:101], v11 offset:46112
  ds_read_b64_tr_b16 v[102:103], v11 offset:48672
  ds_read_b64_tr_b16 v[104:105], v11 offset:46144
  ds_read_b64_tr_b16 v[106:107], v11 offset:48704
  ds_read_b64_tr_b16 v[108:109], v11 offset:46176
  ds_read_b64_tr_b16 v[110:111], v11 offset:48736
  ds_read_b64_tr_b16 v[112:113], v11 offset:46208
  ds_read_b64_tr_b16 v[114:115], v11 offset:48768
  s_waitcnt vmcnt(3) lgkmcnt(5)
  v_mfma_f32_16x16x32_bf16 v[16:19], v[36:39], v[236:239], v[16:19]
  v_mfma_f32_16x16x32_bf16 v[20:23], v[40:43], v[236:239], v[20:23]
  v_mfma_f32_16x16x32_bf16 v[24:27], v[44:47], v[236:239], v[24:27]
  v_mfma_f32_16x16x32_bf16 v[28:31], v[48:51], v[236:239], v[28:31]
  v_mfma_f32_16x16x32_bf16 v[32:35], v[52:55], v[236:239], v[32:35]
  s_waitcnt vmcnt(2) lgkmcnt(10)
  v_mfma_f32_16x16x32_bf16 v[16:19], v[56:59], v[240:243], v[16:19]
  v_mfma_f32_16x16x32_bf16 v[20:23], v[60:63], v[240:243], v[20:23]
  v_mfma_f32_16x16x32_bf16 v[24:27], v[64:67], v[240:243], v[24:27]
  v_mfma_f32_16x16x32_bf16 v[28:31], v[68:71], v[240:243], v[28:31]
  v_mfma_f32_16x16x32_bf16 v[32:35], v[72:75], v[240:243], v[32:35]
  s_waitcnt vmcnt(1) lgkmcnt(0)
  v_mfma_f32_16x16x32_bf16 v[16:19], v[76:79], v[244:247], v[16:19]
  v_mfma_f32_16x16x32_bf16 v[20:23], v[80:83], v[244:247], v[20:23]
  v_mfma_f32_16x16x32_bf16 v[24:27], v[84:87], v[244:247], v[24:27]
  v_mfma_f32_16x16x32_bf16 v[28:31], v[88:91], v[244:247], v[28:31]
  v_mfma_f32_16x16x32_bf16 v[32:35], v[92:95], v[244:247], v[32:35]
  s_waitcnt vmcnt(0)
  v_mfma_f32_16x16x32_bf16 v[16:19], v[96:99], v[248:251], v[16:19]
  v_mfma_f32_16x16x32_bf16 v[20:23], v[100:103], v[248:251], v[20:23]
  v_mfma_f32_16x16x32_bf16 v[24:27], v[104:107], v[248:251], v[24:27]
  v_mfma_f32_16x16x32_bf16 v[28:31], v[108:111], v[248:251], v[28:31]
  v_mfma_f32_16x16x32_bf16 v[32:35], v[112:115], v[248:251], v[32:35]
  s_nop 3
  v_cvt_pk_bf16_f32 v16, v16, v17
  v_and_b32 v17, 0xffff0000, v16
  v_lshlrev_b32 v16, 16, v16
  v_pk_mul_f32 v[16:17], v[16:17], v[136:137]
  v_cvt_pk_bf16_f32 v16, v16, v17
  v_and_b32 v17, 0xffff0000, v16
  v_lshlrev_b32 v16, 16, v16
  v_pk_add_f32 v[16:17], v[16:17], v[116:117]
  v_cvt_pk_bf16_f32 v36, v16, v17
  v_cvt_pk_bf16_f32 v18, v18, v19
  v_and_b32 v19, 0xffff0000, v18
  v_lshlrev_b32 v18, 16, v18
  v_pk_mul_f32 v[18:19], v[18:19], v[138:139]
  v_cvt_pk_bf16_f32 v18, v18, v19
  v_and_b32 v19, 0xffff0000, v18
  v_lshlrev_b32 v18, 16, v18
  v_pk_add_f32 v[18:19], v[18:19], v[118:119]
  v_cvt_pk_bf16_f32 v37, v18, v19
  buffer_store_dwordx2 v[36:37], v8, s[12:15], s41 offen offset:0
  v_cvt_pk_bf16_f32 v20, v20, v21
  v_and_b32 v21, 0xffff0000, v20
  v_lshlrev_b32 v20, 16, v20
  v_pk_mul_f32 v[20:21], v[20:21], v[140:141]
  v_cvt_pk_bf16_f32 v20, v20, v21
  v_and_b32 v21, 0xffff0000, v20
  v_lshlrev_b32 v20, 16, v20
  v_pk_add_f32 v[20:21], v[20:21], v[120:121]
  v_cvt_pk_bf16_f32 v38, v20, v21
  v_cvt_pk_bf16_f32 v22, v22, v23
  v_and_b32 v23, 0xffff0000, v22
  v_lshlrev_b32 v22, 16, v22
  v_pk_mul_f32 v[22:23], v[22:23], v[142:143]
  v_cvt_pk_bf16_f32 v22, v22, v23
  v_and_b32 v23, 0xffff0000, v22
  v_lshlrev_b32 v22, 16, v22
  v_pk_add_f32 v[22:23], v[22:23], v[122:123]
  v_cvt_pk_bf16_f32 v39, v22, v23
  buffer_store_dwordx2 v[38:39], v8, s[12:15], s41 offen offset:32
  v_cvt_pk_bf16_f32 v24, v24, v25
  v_and_b32 v25, 0xffff0000, v24
  v_lshlrev_b32 v24, 16, v24
  v_pk_mul_f32 v[24:25], v[24:25], v[144:145]
  v_cvt_pk_bf16_f32 v24, v24, v25
  v_and_b32 v25, 0xffff0000, v24
  v_lshlrev_b32 v24, 16, v24
  v_pk_add_f32 v[24:25], v[24:25], v[124:125]
  v_cvt_pk_bf16_f32 v40, v24, v25
  v_cvt_pk_bf16_f32 v26, v26, v27
  v_and_b32 v27, 0xffff0000, v26
  v_lshlrev_b32 v26, 16, v26
  v_pk_mul_f32 v[26:27], v[26:27], v[146:147]
  v_cvt_pk_bf16_f32 v26, v26, v27
  v_and_b32 v27, 0xffff0000, v26
  v_lshlrev_b32 v26, 16, v26
  v_pk_add_f32 v[26:27], v[26:27], v[126:127]
  v_cvt_pk_bf16_f32 v41, v26, v27
  buffer_store_dwordx2 v[40:41], v8, s[12:15], s41 offen offset:64
  v_cvt_pk_bf16_f32 v28, v28, v29
  v_and_b32 v29, 0xffff0000, v28
  v_lshlrev_b32 v28, 16, v28
  v_pk_mul_f32 v[28:29], v[28:29], v[148:149]
  v_cvt_pk_bf16_f32 v28, v28, v29
  v_and_b32 v29, 0xffff0000, v28
  v_lshlrev_b32 v28, 16, v28
  v_pk_add_f32 v[28:29], v[28:29], v[128:129]
  v_cvt_pk_bf16_f32 v42, v28, v29
  v_cvt_pk_bf16_f32 v30, v30, v31
  v_and_b32 v31, 0xffff0000, v30
  v_lshlrev_b32 v30, 16, v30
  v_pk_mul_f32 v[30:31], v[30:31], v[150:151]
  v_cvt_pk_bf16_f32 v30, v30, v31
  v_and_b32 v31, 0xffff0000, v30
  v_lshlrev_b32 v30, 16, v30
  v_pk_add_f32 v[30:31], v[30:31], v[130:131]
  v_cvt_pk_bf16_f32 v43, v30, v31
  buffer_store_dwordx2 v[42:43], v8, s[12:15], s41 offen offset:96
  v_cvt_pk_bf16_f32 v32, v32, v33
  v_and_b32 v33, 0xffff0000, v32
  v_lshlrev_b32 v32, 16, v32
  v_pk_mul_f32 v[32:33], v[32:33], v[152:153]
  v_cvt_pk_bf16_f32 v32, v32, v33
  v_and_b32 v33, 0xffff0000, v32
  v_lshlrev_b32 v32, 16, v32
  v_pk_add_f32 v[32:33], v[32:33], v[132:133]
  v_cvt_pk_bf16_f32 v44, v32, v33
  v_cvt_pk_bf16_f32 v34, v34, v35
  v_and_b32 v35, 0xffff0000, v34
  v_lshlrev_b32 v34, 16, v34
  v_pk_mul_f32 v[34:35], v[34:35], v[154:155]
  v_cvt_pk_bf16_f32 v34, v34, v35
  v_and_b32 v35, 0xffff0000, v34
  v_lshlrev_b32 v34, 16, v34
  v_pk_add_f32 v[34:35], v[34:35], v[134:135]
  v_cvt_pk_bf16_f32 v45, v34, v35
  buffer_store_dwordx2 v[44:45], v8, s[12:15], s41 offen offset:128
  s_endpgm
KF_FB:
  v_mov_b32 v102, 0
  v_mov_b32 v110, 0
  v_mov_b32 v12, 0xff800000
  v_mov_b32 v10, 0xff800000
  v_subrev_u32 v144, 102400, v144
  v_subrev_u32 v145, 102400, v145
  v_subrev_u32 v146, 102400, v146
  s_mov_b32 s42, 0
KF_FB1:
  buffer_load_dwordx4 v[112:115], v144, s[8:11], s42 offen
  buffer_load_dwordx2 v[116:117], v145, s[8:11], s42 offen
  s_add_u32 s42, s42, 2688
  s_waitcnt vmcnt(0)
  v_mfma_f32_32x32x16_bf16 v[16:31], v[112:115], v[96:99], 0
  v_mfma_f32_32x32x16_bf16 v[16:31], v[116:119], v[100:103], v[16:31]
  v_mfma_f32_32x32x16_bf16 v[32:47], v[112:115], v[104:107], 0
  v_mfma_f32_32x32x16_bf16 v[32:47], v[116:119], v[108:111], v[32:47]
  s_nop 9
  v_max3_f32 v12, v12, v16, v17
  v_max3_f32 v12, v12, v18, v19
  v_max3_f32 v12, v12, v20, v21
  v_max3_f32 v12, v12, v22, v23
  v_max3_f32 v12, v12, v24, v25
  v_max3_f32 v12, v12, v26, v27
  v_max3_f32 v12, v12, v28, v29
  v_max3_f32 v12, v12, v30, v31
  v_max3_f32 v10, v10, v32, v33
  v_max3_f32 v10, v10, v34, v35
  v_max3_f32 v10, v10, v36, v37
  v_max3_f32 v10, v10, v38, v39
  v_max3_f32 v10, v10, v40, v41
  v_max3_f32 v10, v10, v42, v43
  v_max3_f32 v10, v10, v44, v45
  v_max3_f32 v10, v10, v46, v47
  s_cmp_lt_u32 s42, 172032
  s_cbranch_scc1 KF_FB1
  v_mov_b32 v13, v12
  s_nop 1
  v_permlane32_swap_b32 v12, v13
  v_max_f32 v12, v12, v13
  v_mov_b32 v11, v10
  s_nop 1
  v_permlane32_swap_b32 v10, v11
  v_max_f32 v10, v10, v11
  v_mov_b32 v48, 0
  v_mov_b32 v49, 0
  v_mov_b32 v50, 0
  v_mov_b32 v51, 0
  v_mov_b32 v52, 0
  v_mov_b32 v53, 0
  v_mov_b32 v54, 0
  v_mov_b32 v55, 0
  v_mov_b32 v56, 0
  v_mov_b32 v57, 0
  v_mov_b32 v58, 0
  v_mov_b32 v59, 0
  v_mov_b32 v60, 0
  v_mov_b32 v61, 0
  v_mov_b32 v62, 0
  v_mov_b32 v63, 0
  v_mov_b32 v64, 0
  v_mov_b32 v65, 0
  v_mov_b32 v66, 0
  v_mov_b32 v67, 0
  v_mov_b32 v68, 0
  v_mov_b32 v69, 0
  v_mov_b32 v70, 0
  v_mov_b32 v71, 0
  v_mov_b32 v72, 0
  v_mov_b32 v73, 0
  v_mov_b32 v74, 0
  v_mov_b32 v75, 0
  v_mov_b32 v76, 0
  v_mov_b32 v77, 0
  v_mov_b32 v78, 0
  v_mov_b32 v79, 0
  s_mov_b32 s42, 0
KF_FB2:
  buffer_load_dwordx4 v[112:115], v144, s[8:11], s42 offen
  buffer_load_dwordx2 v[116:117], v145, s[8:11], s42 offen
  buffer_load_dwordx4 v[128:131], v146, s[8:11], s42 offen
  buffer_load_dwordx4 v[132:135], v146, s[8:11], s42 offen offset:672
  s_add_u32 s42, s42, 2688
  s_waitcnt vmcnt(0)
  v_mfma_f32_32x32x16_bf16 v[16:31], v[112:115], v[96:99], 0
  v_mfma_f32_32x32x16_bf16 v[16:31], v[116:119], v[100:103], v[16:31]
  v_mfma_f32_32x32x16_bf16 v[32:47], v[112:115], v[104:107], 0
  v_mfma_f32_32x32x16_bf16 v[32:47], v[116:119], v[108:111], v[32:47]
  s_nop 9
  v_sub_f32 v16, v16, v12
  v_sub_f32 v17, v17, v12
  v_sub_f32 v18, v18, v12
  v_sub_f32 v19, v19, v12
  v_sub_f32 v20, v20, v12
  v_sub_f32 v21, v21, v12
  v_sub_f32 v22, v22, v12
  v_sub_f32 v23, v23, v12
  v_sub_f32 v24, v24, v12
  v_sub_f32 v25, v25, v12
  v_sub_f32 v26, v26, v12
  v_sub_f32 v27, v27, v12
  v_sub_f32 v28, v28, v12
  v_sub_f32 v29, v29, v12
  v_sub_f32 v30, v30, v12
  v_sub_f32 v31, v31, v12
  v_exp_f32 v16, v16
  v_exp_f32 v17, v17
  v_exp_f32 v18, v18
  v_exp_f32 v19, v19
  v_exp_f32 v20, v20
  v_exp_f32 v21, v21
  v_exp_f32 v22, v22
  v_exp_f32 v23, v23
  v_exp_f32 v24, v24
  v_exp_f32 v25, v25
  v_exp_f32 v26, v26
  v_exp_f32 v27, v27
  v_exp_f32 v28, v28
  v_exp_f32 v29, v29
  v_exp_f32 v30, v30
  v_exp_f32 v31, v31
  v_cvt_pk_bf16_f32 v80, v16, v17
  v_cvt_pk_bf16_f32 v81, v18, v19
  v_cvt_pk_bf16_f32 v82, v20, v21
  v_cvt_pk_bf16_f32 v83, v22, v23
  v_cvt_pk_bf16_f32 v84, v24, v25
  v_cvt_pk_bf16_f32 v85, v26, v27
  v_cvt_pk_bf16_f32 v86, v28, v29
  v_cvt_pk_bf16_f32 v87, v30, v31
  v_mfma_f32_32x32x16_bf16 v[48:63], v[128:131], v[80:83], v[48:63]
  s_nop 0
  v_mfma_f32_32x32x16_bf16 v[48:63], v[132:135], v[84:87], v[48:63]
  v_sub_f32 v32, v32, v10
  v_sub_f32 v33, v33, v10
  v_sub_f32 v34, v34, v10
  v_sub_f32 v35, v35, v10
  v_sub_f32 v36, v36, v10
  v_sub_f32 v37, v37, v10
  v_sub_f32 v38, v38, v10
  v_sub_f32 v39, v39, v10
  v_sub_f32 v40, v40, v10
  v_sub_f32 v41, v41, v10
  v_sub_f32 v42, v42, v10
  v_sub_f32 v43, v43, v10
  v_sub_f32 v44, v44, v10
  v_sub_f32 v45, v45, v10
  v_sub_f32 v46, v46, v10
  v_sub_f32 v47, v47, v10
  v_exp_f32 v32, v32
  v_exp_f32 v33, v33
  v_exp_f32 v34, v34
  v_exp_f32 v35, v35
  v_exp_f32 v36, v36
  v_exp_f32 v37, v37
  v_exp_f32 v38, v38
  v_exp_f32 v39, v39
  v_exp_f32 v40, v40
  v_exp_f32 v41, v41
  v_exp_f32 v42, v42
  v_exp_f32 v43, v43
  v_exp_f32 v44, v44
  v_exp_f32 v45, v45
  v_exp_f32 v46, v46
  v_exp_f32 v47, v47
  v_cvt_pk_bf16_f32 v88, v32, v33
  v_cvt_pk_bf16_f32 v89, v34, v35
  v_cvt_pk_bf16_f32 v90, v36, v37
  v_cvt_pk_bf16_f32 v91, v38, v39
  v_cvt_pk_bf16_f32 v92, v40, v41
  v_cvt_pk_bf16_f32 v93, v42, v43
  v_cvt_pk_bf16_f32 v94, v44, v45
  v_cvt_pk_bf16_f32 v95, v46, v47
  v_mfma_f32_32x32x16_bf16 v[64:79], v[128:131], v[88:91], v[64:79]
  s_nop 0
  v_mfma_f32_32x32x16_bf16 v[64:79], v[132:135], v[92:95], v[64:79]
  s_cmp_lt_u32 s42, 172032
  s_cbranch_scc1 KF_FB2
  s_branch KF_STORE
KF_HELP:
  v_lshlrev_b32 v98, 4, v2
  v_lshlrev_b32 v99, 2, v2
  s_mov_b32 s22, 25600
  s_mov_b32 s26, 256
  s_mov_b32 s27, 0x20000
  s_mov_b32 s30, 1280
  s_mov_b32 s31, 0x20000
  s_lshl_b32 s40, s34, 10
  s_bitcmp1_b32 s33, 0
  s_waitcnt lgkmcnt(0)
  s_cselect_b64 s[20:21], s[54:55], s[52:53]
  s_mov_b64 s[28:29], s[60:61]
  s_mov_b64 s[24:25], s[70:71]
  s_mov_b64 s[16:17], s[50:51]
  s_mov_b64 s[8:9], s[72:73]
  s_mov_b64 s[4:5], s[48:49]
  s_cmp_lg_u32 s34, 3
  s_cbranch_scc1 KF_HE
  s_cmp_lg_u32 s2, 0
  s_cbranch_scc1 KF_NN
  s_memrealtime s[76:77]
  v_mov_b32 v46, 0
  s_waitcnt lgkmcnt(0)
  s_or_b32 s77, s77, 0x80000000
  v_mov_b32 v44, s76
  v_mov_b32 v45, s77
  s_mov_b64 exec, 1
  buffer_store_dwordx2 v[44:45], v46, s[24:27], 0 offen sc1
  s_mov_b64 exec, -1
  s_waitcnt vmcnt(0)
KF_NN:
  buffer_load_dword v16, v99, s[28:31], 0 offen offset:0
  buffer_load_dword v17, v99, s[28:31], 0 offen offset:256
  buffer_load_dword v18, v99, s[28:31], 0 offen offset:512
  buffer_load_dword v19, v99, s[28:31], 0 offen offset:768
  buffer_load_dword v20, v99, s[28:31], 0 offen offset:1024
KF_HE:
  s_cmp_ge_u32 s33, 2
  s_cbranch_scc1 KF_HNE
  s_add_u32 m0, s40, 102400
  s_add_u32 s41, s40, 0
  buffer_load_dwordx4 v98, s[20:23], s41 offen lds
  s_add_u32 m0, s40, 106496
  s_add_u32 s41, s40, 4096
  buffer_load_dwordx4 v98, s[20:23], s41 offen lds
  s_add_u32 m0, s40, 110592
  s_add_u32 s41, s40, 8192
  buffer_load_dwordx4 v98, s[20:23], s41 offen lds
  s_add_u32 m0, s40, 114688
  s_add_u32 s41, s40, 12288
  buffer_load_dwordx4 v98, s[20:23], s41 offen lds
  s_add_u32 m0, s40, 118784
  s_add_u32 s41, s40, 16384
  buffer_load_dwordx4 v98, s[20:23], s41 offen lds
  s_add_u32 m0, s40, 122880
  s_add_u32 s41, s40, 20480
  buffer_load_dwordx4 v98, s[20:23], s41 offen lds
  s_add_u32 m0, s40, 126976
  s_add_u32 s41, s40, 24576
  buffer_load_dwordx4 v98, s[20:23], s41 offen lds
KF_HNE:
  s_cmp_eq_u32 s34, 3
  s_cbranch_scc1 KF_H3
  v_add_u32 v68, 0, v2
  v_mul_u32_u24 v69, 6554, v68
  v_lshrrev_b32 v69, 16, v69
  v_mul_u32_u24 v70, 10, v69
  v_sub_u32 v70, v68, v70
  v_lshlrev_b32 v70, 4, v70
  v_add_u32 v70, s35, v70
  v_bfe_u32 v71, v69, 2, 1
  v_bfe_u32 v72, v69, 3, 1
  v_and_b32 v73, 3, v69
  v_lshrrev_b32 v69, 4, v69
  v_mad_u32_u24 v74, v71, 8, v73
  v_mov_b32 v68, 16
  v_mad_u32_u24 v74, v72, v68, v74
  v_mad_u32_u24 v74, v69, 4, v74
  v_add_u32 v74, 0, v74
  v_mul_u32_u24 v74, 1280, v74
  v_add_u32 v16, v74, v70
  v_add_u32 v68, 64, v2
  v_mul_u32_u24 v69, 6554, v68
  v_lshrrev_b32 v69, 16, v69
  v_mul_u32_u24 v70, 10, v69
  v_sub_u32 v70, v68, v70
  v_lshlrev_b32 v70, 4, v70
  v_add_u32 v70, s35, v70
  v_bfe_u32 v71, v69, 2, 1
  v_bfe_u32 v72, v69, 3, 1
  v_and_b32 v73, 3, v69
  v_lshrrev_b32 v69, 4, v69
  v_mad_u32_u24 v74, v71, 8, v73
  v_mov_b32 v68, 16
  v_mad_u32_u24 v74, v72, v68, v74
  v_mad_u32_u24 v74, v69, 4, v74
  v_add_u32 v74, 0, v74
  v_mul_u32_u24 v74, 1280, v74
  v_add_u32 v17, v74, v70
  v_add_u32 v68, 128, v2
  v_mul_u32_u24 v69, 6554, v68
  v_lshrrev_b32 v69, 16, v69
  v_mul_u32_u24 v70, 10, v69
  v_sub_u32 v70, v68, v70
  v_lshlrev_b32 v70, 4, v70
  v_add_u32 v70, s35, v70
  v_bfe_u32 v71, v69, 2, 1
  v_bfe_u32 v72, v69, 3, 1
  v_and_b32 v73, 3, v69
  v_lshrrev_b32 v69, 4, v69
  v_mad_u32_u24 v74, v71, 8, v73
  v_mov_b32 v68, 16
  v_mad_u32_u24 v74, v72, v68, v74
  v_mad_u32_u24 v74, v69, 4, v74
  v_add_u32 v74, 0, v74
  v_mul_u32_u24 v74, 1280, v74
  v_add_u32 v18, v74, v70
  v_add_u32 v68, 192, v2
  v_mul_u32_u24 v69, 6554, v68
  v_lshrrev_b32 v69, 16, v69
  v_mul_u32_u24 v70, 10, v69
  v_sub_u32 v70, v68, v70
  v_lshlrev_b32 v70, 4, v70
  v_add_u32 v70, s35, v70
  v_bfe_u32 v71, v69, 2, 1
  v_bfe_u32 v72, v69, 3, 1
  v_and_b32 v73, 3, v69
  v_lshrrev_b32 v69, 4, v69
  v_mad_u32_u24 v74, v71, 8, v73
  v_mov_b32 v68, 16
  v_mad_u32_u24 v74, v72, v68, v74
  v_mad_u32_u24 v74, v69, 4, v74
  v_add_u32 v74, 0, v74
  v_mul_u32_u24 v74, 1280, v74
  v_add_u32 v19, v74, v70
  v_add_u32 v68, 256, v2
  v_mul_u32_u24 v69, 6554, v68
  v_lshrrev_b32 v69, 16, v69
  v_mul_u32_u24 v70, 10, v69
  v_sub_u32 v70, v68, v70
  v_lshlrev_b32 v70, 4, v70
  v_add_u32 v70, s35, v70
  v_bfe_u32 v71, v69, 2, 1
  v_bfe_u32 v72, v69, 3, 1
  v_and_b32 v73, 3, v69
  v_lshrrev_b32 v69, 4, v69
  v_mad_u32_u24 v74, v71, 8, v73
  v_mov_b32 v68, 16
  v_mad_u32_u24 v74, v72, v68, v74
  v_mad_u32_u24 v74, v69, 4, v74
  v_add_u32 v74, 0, v74
  v_mul_u32_u24 v74, 1280, v74
  v_add_u32 v20, v74, v70
  v_mul_u32_u24 v9, 3456, v2
  s_mul_i32 s38, s36, 27
  s_add_u32 s38, s38, s37
  s_lshl_b32 s79, s38, 4
  s_cmp_lt_u32 s37, 27
  s_cselect_b32 s14, 2211840, 0
  s_mov_b64 s[12:13], s[62:63]
  s_mul_i32 s40, s34, 40960
  s_mul_i32 s41, s34, 5120
  s_lshl_b32 s42, s34, 2
  s_add_u32 s42, s42, 151808
  v_mov_b32 v12, s42
  s_waitcnt vmcnt(0)
  s_barrier
  s_add_u32 m0, s41, 0
  s_nop 0
  buffer_load_dwordx4 v16, s[16:19], s40 offen lds
  s_add_u32 m0, s41, 1024
  s_nop 0
  buffer_load_dwordx4 v17, s[16:19], s40 offen lds
  s_add_u32 m0, s41, 2048
  s_nop 0
  buffer_load_dwordx4 v18, s[16:19], s40 offen lds
  s_add_u32 m0, s41, 3072
  s_nop 0
  buffer_load_dwordx4 v19, s[16:19], s40 offen lds
  s_add_u32 m0, s41, 4096
  s_nop 0
  buffer_load_dwordx4 v20, s[16:19], s40 offen lds
  s_add_u32 s40, s40, 122880
  s_add_u32 s41, s41, 15360
  s_add_u32 m0, s41, 0
  s_nop 0
  buffer_load_dwordx4 v16, s[16:19], s40 offen lds
  s_add_u32 m0, s41, 1024
  s_nop 0
  buffer_load_dwordx4 v17, s[16:19], s40 offen lds
  s_add_u32 m0, s41, 2048
  s_nop 0
  buffer_load_dwordx4 v18, s[16:19], s40 offen lds
  s_add_u32 m0, s41, 3072
  s_nop 0
  buffer_load_dwordx4 v19, s[16:19], s40 offen lds
  s_add_u32 m0, s41, 4096
  s_nop 0
  buffer_load_dwordx4 v20, s[16:19], s40 offen lds
  s_add_u32 s40, s40, 122880
  s_add_u32 s41, s41, 15360
  s_add_u32 m0, s41, 0
  s_nop 0
  buffer_load_dwordx4 v16, s[16:19], s40 offen lds
  s_add_u32 m0, s41, 1024
  s_nop 0
  buffer_load_dwordx4 v17, s[16:19], s40 offen lds
  s_add_u32 m0, s41, 2048
  s_nop 0
  buffer_load_dwordx4 v18, s[16:19], s40 offen lds
  s_add_u32 m0, s41, 3072
  s_nop 0
  buffer_load_dwordx4 v19, s[16:19], s40 offen lds
  s_add_u32 m0, s41, 4096
  s_nop 0
  buffer_load_dwordx4 v20, s[16:19], s40 offen lds
  s_add_u32 s40, s40, 122880
  s_add_u32 s41, s41, 15360
  s_add_u32 m0, s41, 0
  s_nop 0
  buffer_load_dwordx4 v16, s[16:19], s40 offen lds
  s_add_u32 m0, s41, 1024
  s_nop 0
  buffer_load_dwordx4 v17, s[16:19], s40 offen lds
  s_add_u32 m0, s41, 2048
  s_nop 0
  buffer_load_dwordx4 v18, s[16:19], s40 offen lds
  s_add_u32 m0, s41, 3072
  s_nop 0
  buffer_load_dwordx4 v19, s[16:19], s40 offen lds
  s_add_u32 m0, s41, 4096
  s_nop 0
  buffer_load_dwordx4 v20, s[16:19], s40 offen lds
  s_add_u32 s40, s40, 122880
  s_add_u32 s41, s41, 15360
  s_add_u32 m0, s41, 0
  s_nop 0
  buffer_load_dwordx4 v16, s[16:19], s40 offen lds
  s_add_u32 m0, s41, 1024
  s_nop 0
  buffer_load_dwordx4 v17, s[16:19], s40 offen lds
  s_add_u32 m0, s41, 2048
  s_nop 0
  buffer_load_dwordx4 v18, s[16:19], s40 offen lds
  s_add_u32 m0, s41, 3072
  s_nop 0
  buffer_load_dwordx4 v19, s[16:19], s40 offen lds
  s_add_u32 m0, s41, 4096
  s_nop 0
  buffer_load_dwordx4 v20, s[16:19], s40 offen lds
  s_add_u32 s40, s40, 122880
  s_add_u32 s41, s41, 15360
  s_add_u32 m0, s41, 0
  s_nop 0
  buffer_load_dwordx4 v16, s[16:19], s40 offen lds
  s_add_u32 m0, s41, 1024
  s_nop 0
  buffer_load_dwordx4 v17, s[16:19], s40 offen lds
  s_add_u32 m0, s41, 2048
  s_nop 0
  buffer_load_dwordx4 v18, s[16:19], s40 offen lds
  s_add_u32 m0, s41, 3072
  s_nop 0
  buffer_load_dwordx4 v19, s[16:19], s40 offen lds
  s_add_u32 m0, s41, 4096
  s_nop 0
  buffer_load_dwordx4 v20, s[16:19], s40 offen lds
  s_add_u32 s40, s40, 122880
  s_add_u32 s41, s41, 15360
  s_min_u32 s40, s40, 778240
  s_min_u32 s41, s41, 97280
  s_add_u32 m0, s41, 0
  s_nop 0
  buffer_load_dwordx4 v16, s[16:19], s40 offen lds
  s_add_u32 m0, s41, 1024
  s_nop 0
  buffer_load_dwordx4 v17, s[16:19], s40 offen lds
  s_add_u32 m0, s41, 2048
  s_nop 0
  buffer_load_dwordx4 v18, s[16:19], s40 offen lds
  s_add_u32 m0, s41, 3072
  s_nop 0
  buffer_load_dwordx4 v19, s[16:19], s40 offen lds
  s_add_u32 m0, s41, 4096
  s_nop 0
  buffer_load_dwordx4 v20, s[16:19], s40 offen lds
  s_add_u32 s40, s40, 122880
  s_add_u32 s41, s41, 15360
  v_mov_b32 v68, 2
  s_waitcnt vmcnt(25)
  ds_write_b32 v12, v68
  v_mov_b32 v68, 4
  s_waitcnt vmcnt(15)
  ds_write_b32 v12, v68
  v_mov_b32 v68, 6
  s_waitcnt vmcnt(5)
  ds_write_b32 v12, v68
  v_mov_b32 v68, 7
  s_waitcnt vmcnt(0)
  ds_write_b32 v12, v68
  v_mov_b32 v14, 151808
KF_PDW:
  ds_read_b32 v13, v14 offset:40
  s_waitcnt lgkmcnt(0)
  v_readfirstlane_b32 s43, v13
  s_nop 0
  s_cmp_lg_u32 s43, 0
  s_cbranch_scc1 KF_PDG
  s_sleep 2
  s_branch KF_PDW
KF_PDG:
  s_add_u32 s78, s34, 0
  s_min_u32 s78, s78, 19
  s_sub_u32 s76, s78, 10
  s_cselect_b32 s76, s78, s76
  s_mul_i32 s76, s76, 221184
  s_add_u32 s76, s76, s79
  buffer_load_dwordx4 v[140:143], v9, s[12:15], s76 offen
  s_add_u32 s78, s34, 3
  s_min_u32 s78, s78, 19
  s_sub_u32 s76, s78, 10
  s_cselect_b32 s76, s78, s76
  s_mul_i32 s76, s76, 221184
  s_add_u32 s76, s76, s79
  buffer_load_dwordx4 v[144:147], v9, s[12:15], s76 offen
  s_add_u32 s78, s34, 6
  s_min_u32 s78, s78, 19
  s_sub_u32 s76, s78, 10
  s_cselect_b32 s76, s78, s76
  s_mul_i32 s76, s76, 221184
  s_add_u32 s76, s76, s79
  buffer_load_dwordx4 v[148:151], v9, s[12:15], s76 offen
  s_branch KF_HJ
KF_H3:
  v_mov_b32 v28, 0
  v_mov_b32 v29, 0
  v_mov_b32 v30, 0
  v_mov_b32 v31, 0
  v_mov_b32 v14, 151808
  ds_write_b128 v14, v[28:31]
  ds_write_b128 v14, v[28:31] offset:16
  s_cmp_ge_u32 s33, 2
  s_cselect_b32 s40, 1, 0
  v_mov_b32 v11, s40
  ds_write_b32 v14, v11 offset:40
  ds_write_b32 v14, v11 offset:44
  v_lshrrev_b32 v7, 4, v2
  v_mul_u32_u24 v7, 320, v7
  v_bfe_u32 v8, v2, 1, 1
  v_mul_u32_u24 v8, 160, v8
  v_add_u32 v7, v8, v7
  v_bfe_u32 v8, v2, 2, 2
  v_lshl_add_u32 v7, v8, 5, v7
  v_and_b32 v8, 1, v2
  v_lshl_add_u32 v7, v8, 4, v7
  v_add_u32 v7, 145408, v7
  v_lshlrev_b32 v40, 3, v2
  s_cmp_eq_u32 s33, 0
  s_cselect_b32 s40, 0, 0x40000000
  s_cselect_b32 s41, 8, 0
  v_add_u32 v40, s40, v40
  v_cmp_gt_u32 vcc, s41, v2
  v_mov_b32 v41, 0x40000000
  s_nop 0
  v_cndmask_b32 v41, v41, v99, vcc
  s_lshl_b32 s44, s32, 9
  s_add_u32 s44, s44, 196608
  s_lshl_b32 s45, s32, 5
  s_add_u32 s45, s45, 192512
  s_cmp_ge_u32 s33, 2
  s_cbranch_scc0 KF_H3W
  s_waitcnt vmcnt(0)
KF_H3W:
  s_waitcnt vmcnt(7)
  v_mov_b32 v46, 0
  buffer_load_dwordx2 v[44:45], v46, s[24:27], 0 offen sc1
  v_and_b32 v32, 0xffff, v16
  v_or_b32 v32, 0x3f800000, v32
  v_mov_b32 v33, 0
  v_lshrrev_b32 v34, 16, v16
  v_or_b32 v34, 0x3f800000, v34
  v_mov_b32 v35, 0
  ds_write_b128 v7, v[32:35] offset:0
  v_and_b32 v36, 0xffff, v17
  v_or_b32 v36, 0x3f800000, v36
  v_mov_b32 v37, 0
  v_lshrrev_b32 v38, 16, v17
  v_or_b32 v38, 0x3f800000, v38
  v_mov_b32 v39, 0
  ds_write_b128 v7, v[36:39] offset:1280
  v_and_b32 v32, 0xffff, v18
  v_or_b32 v32, 0x3f800000, v32
  v_mov_b32 v33, 0
  v_lshrrev_b32 v34, 16, v18
  v_or_b32 v34, 0x3f800000, v34
  v_mov_b32 v35, 0
  ds_write_b128 v7, v[32:35] offset:2560
  v_and_b32 v36, 0xffff, v19
  v_or_b32 v36, 0x3f800000, v36
  v_mov_b32 v37, 0
  v_lshrrev_b32 v38, 16, v19
  v_or_b32 v38, 0x3f800000, v38
  v_mov_b32 v39, 0
  ds_write_b128 v7, v[36:39] offset:3840
  v_and_b32 v32, 0xffff, v20
  v_or_b32 v32, 0x3f800000, v32
  v_mov_b32 v33, 0
  v_lshrrev_b32 v34, 16, v20
  v_or_b32 v34, 0x3f800000, v34
  v_mov_b32 v35, 0
  ds_write_b128 v7, v[32:35] offset:5120
  s_mul_i32 s40, s33, 1280
  s_add_u32 s41, s40, 128000
  v_add_u32 v7, s41, v98
  s_mul_i32 s41, s32, 5376
  s_add_u32 s40, s40, s41
  s_add_u32 s40, s40, 0
  s_cmp_eq_u32 s33, 0
  s_cselect_b32 s41, 16, 20
  s_cselect_b32 s42, 33, 0
  v_mov_b32 v10, 0x40000000
  v_cmp_gt_u32 vcc, s41, v2
  s_nop 1
  v_cndmask_b32 v8, v10, v98, vcc
  v_cmp_gt_u32 vcc, s42, v2
  s_nop 1
  v_cndmask_b32 v9, v10, v98, vcc
  v_add_u32 v10, 133376, v98
  s_mul_i32 s41, s32, 640
  s_add_u32 s41, s41, 172032
  s_lshl_b32 s42, s32, 8
  s_lshl_b32 s43, s33, 7
  s_add_u32 s42, s42, s43
  s_add_u32 s42, s42, 229376
  v_mov_b32 v11, 1
  v_mov_b32 v12, 0
  v_lshlrev_b32 v46, 3, v2
  v_lshlrev_b32 v47, 7, v2
  s_mov_b32 s47, 131072
  s_waitcnt vmcnt(0) lgkmcnt(0)
  s_barrier
KF_NW:
  v_readfirstlane_b32 s76, v44
  v_readfirstlane_b32 s77, v45
  s_nop 0
  s_cmp_lg_u32 s77, 0
  s_cbranch_scc1 KF_NOK
  buffer_load_dwordx2 v[44:45], v12, s[24:27], 0 offen sc1
  s_sub_u32 s47, s47, 1
  s_cbranch_scc1 KF_NTO
  s_waitcnt vmcnt(0)
  s_branch KF_NW
KF_NTO:
  s_waitcnt vmcnt(0)
  s_mov_b32 s47, 0
KF_NOK:
  s_cmp_ge_u32 s33, 2
  s_cbranch_scc1 KF_POLL0
  buffer_store_dwordx2 v[28:29], v40, s[8:11], s44 offen sc1
  buffer_store_dword v28, v41, s[8:11], s45 offen sc1
KF_PUBW:
  ds_read_b128 v[28:31], v14 offset:16
  s_waitcnt lgkmcnt(0)
  v_min3_u32 v28, v28, v29, v30
  v_min_u32 v28, v28, v31
  s_nop 0
  v_readfirstlane_b32 s43, v28
  s_nop 0
  s_cmp_eq_u32 s43, 0
  s_cbranch_scc1 KF_PUBW
  ds_read_b128 v[24:27], v7
  ds_read_b128 v[28:31], v7 offset:1024
  ds_read_b128 v[32:35], v7 offset:2688
  ds_read_b128 v[36:39], v7 offset:3712
  ds_read_b128 v[40:43], v10
  s_waitcnt lgkmcnt(4)
  buffer_store_dwordx4 v[24:27], v98, s[8:11], s40 offen sc1
  s_waitcnt lgkmcnt(3)
  buffer_store_dwordx4 v[28:31], v8, s[8:11], s40 offen offset:1024 sc1
  s_waitcnt lgkmcnt(2)
  buffer_store_dwordx4 v[32:35], v98, s[8:11], s40 offen offset:2688 sc1
  s_waitcnt lgkmcnt(1)
  buffer_store_dwordx4 v[36:39], v8, s[8:11], s40 offen offset:3712 sc1
  s_waitcnt lgkmcnt(0)
  buffer_store_dwordx4 v[40:43], v9, s[8:11], s41 offen sc1
  ds_write_b32 v14, v11 offset:44
  s_waitcnt vmcnt(0)
  s_mov_b64 exec, 0xff
  buffer_store_dwordx2 v[44:45], v46, s[8:11], s42 offen sc1
  s_mov_b64 exec, -1
  ds_write_b32 v14, v11 offset:40
KF_POLL0:
  ds_read_b128 v[28:31], v14
  s_waitcnt lgkmcnt(0)
  v_min3_u32 v28, v28, v29, v30
  s_nop 0
  v_readfirstlane_b32 s43, v28
  s_nop 0
  s_cmp_ge_u32 s43, 4
  s_cbranch_scc1 KF_POLL1P
  s_sleep 1
  s_branch KF_POLL0
KF_POLL1P:
  s_mov_b32 s43, 229376
KF_POLL1:
  s_nop 0
  buffer_load_dwordx2 v[48:49], v47, s[8:11], s43 offen sc1
  s_sub_u32 s47, s47, 1
  s_cbranch_scc1 KF_GO1
  s_waitcnt vmcnt(0)
  v_cmp_eq_u64 vcc, s[76:77], v[48:49]
  s_nop 0
  s_cmp_eq_u64 vcc, exec
  s_cbranch_scc1 KF_GO1
  s_branch KF_POLL1
KF_GO1:
  s_mov_b64 exec, -1
  s_add_u32 s43, s36, 0
  s_and_b32 s43, s43, 7
  s_mul_i32 s43, s43, 21504
  s_mov_b32 m0, 102400
  s_add_u32 s42, s43, 0
  buffer_load_dwordx4 v98, s[8:11], s42 offen offset:0 lds
  buffer_load_dwordx4 v98, s[8:11], s42 offen offset:1024 lds
  buffer_load_dwordx4 v98, s[8:11], s42 offen offset:2048 lds
  buffer_load_dwordx4 v98, s[8:11], s42 offen offset:3072 lds
  s_mov_b32 m0, 106496
  s_add_u32 s42, s43, 4096
  buffer_load_dwordx4 v98, s[8:11], s42 offen offset:0 lds
  buffer_load_dwordx4 v98, s[8:11], s42 offen offset:1024 lds
  buffer_load_dwordx4 v98, s[8:11], s42 offen offset:2048 lds
  buffer_load_dwordx4 v98, s[8:11], s42 offen offset:3072 lds
  s_mov_b32 m0, 110592
  s_add_u32 s42, s43, 8192
  buffer_load_dwordx4 v98, s[8:11], s42 offen offset:0 lds
  buffer_load_dwordx4 v98, s[8:11], s42 offen offset:1024 lds
  buffer_load_dwordx4 v98, s[8:11], s42 offen offset:2048 lds
  buffer_load_dwordx4 v98, s[8:11], s42 offen offset:3072 lds
  s_mov_b32 m0, 114688
  s_add_u32 s42, s43, 12288
  buffer_load_dwordx4 v98, s[8:11], s42 offen offset:0 lds
  buffer_load_dwordx4 v98, s[8:11], s42 offen offset:1024 lds
  buffer_load_dwordx4 v98, s[8:11], s42 offen offset:2048 lds
  buffer_load_dwordx4 v98, s[8:11], s42 offen offset:3072 lds
  s_mov_b32 m0, 118784
  s_add_u32 s42, s43, 16384
  buffer_load_dwordx4 v98, s[8:11], s42 offen offset:0 lds
  buffer_load_dwordx4 v98, s[8:11], s42 offen offset:1024 lds
  buffer_load_dwordx4 v98, s[8:11], s42 offen offset:2048 lds
  buffer_load_dwordx4 v98, s[8:11], s42 offen offset:3072 lds
  s_mov_b32 m0, 122880
  s_add_u32 s42, s43, 20480
  buffer_load_dwordx4 v98, s[8:11], s42 offen offset:0 lds
  s_add_u32 s43, s36, 1
  s_and_b32 s43, s43, 7
  s_mul_i32 s43, s43, 21504
  s_mov_b32 m0, 123904
  s_add_u32 s42, s43, 0
  buffer_load_dwordx4 v98, s[8:11], s42 offen offset:0 lds
  buffer_load_dwordx4 v98, s[8:11], s42 offen offset:1024 lds
  buffer_load_dwordx4 v98, s[8:11], s42 offen offset:2048 lds
  buffer_load_dwordx4 v98, s[8:11], s42 offen offset:3072 lds
  s_mov_b32 m0, 128000
  s_add_u32 s42, s43, 4096
  buffer_load_dwordx4 v98, s[8:11], s42 offen offset:0 lds
  buffer_load_dwordx4 v98, s[8:11], s42 offen offset:1024 lds
  buffer_load_dwordx4 v98, s[8:11], s42 offen offset:2048 lds
  buffer_load_dwordx4 v98, s[8:11], s42 offen offset:3072 lds
  s_mov_b32 m0, 132096
  s_add_u32 s42, s43, 8192
  buffer_load_dwordx4 v98, s[8:11], s42 offen offset:0 lds
  buffer_load_dwordx4 v98, s[8:11], s42 offen offset:1024 lds
  buffer_load_dwordx4 v98, s[8:11], s42 offen offset:2048 lds
  buffer_load_dwordx4 v98, s[8:11], s42 offen offset:3072 lds
  s_mov_b32 m0, 136192
  s_add_u32 s42, s43, 12288
  buffer_load_dwordx4 v98, s[8:11], s42 offen offset:0 lds
  buffer_load_dwordx4 v98, s[8:11], s42 offen offset:1024 lds
  buffer_load_dwordx4 v98, s[8:11], s42 offen offset:2048 lds
  buffer_load_dwordx4 v98, s[8:11], s42 offen offset:3072 lds
  s_mov_b32 m0, 140288
  s_add_u32 s42, s43, 16384
  buffer_load_dwordx4 v98, s[8:11], s42 offen offset:0 lds
  buffer_load_dwordx4 v98, s[8:11], s42 offen offset:1024 lds
  buffer_load_dwordx4 v98, s[8:11], s42 offen offset:2048 lds
  buffer_load_dwordx4 v98, s[8:11], s42 offen offset:3072 lds
  s_mov_b32 m0, 144384
  s_add_u32 s42, s43, 20480
  buffer_load_dwordx4 v98, s[8:11], s42 offen offset:0 lds
  s_waitcnt vmcnt(21)
KF_HJ:
  v_add_u32 v100, 0, v2
  v_mul_u32_u24 v101, 6554, v100
  v_lshrrev_b32 v101, 16, v101
  v_mul_u32_u24 v102, 10, v101
  v_sub_u32 v102, v100, v102
  v_lshlrev_b32 v102, 4, v102
  v_add_u32 v102, s35, v102
  v_bfe_u32 v103, v101, 2, 1
  v_bfe_u32 v104, v101, 3, 1
  v_and_b32 v105, 3, v101
  v_lshrrev_b32 v101, 4, v101
  v_mad_u32_u24 v106, v103, 20, v105
  v_mov_b32 v100, 4
  v_mad_u32_u24 v106, v104, v100, v106
  v_mad_u32_u24 v106, v101, 8, v106
  v_add_u32 v106, 0, v106
  v_mul_u32_u24 v106, 1280, v106
  v_add_u32 v88, v106, v102
  v_mad_u32_u24 v106, v103, 20, v105
  v_mov_b32 v100, 80
  v_mad_u32_u24 v106, v104, v100, v106
  v_mad_u32_u24 v106, v101, 40, v106
  v_add_u32 v106, 16, v106
  v_mul_u32_u24 v106, 1280, v106
  v_add_u32 v93, v106, v102
  v_add_u32 v100, 64, v2
  v_mul_u32_u24 v101, 6554, v100
  v_lshrrev_b32 v101, 16, v101
  v_mul_u32_u24 v102, 10, v101
  v_sub_u32 v102, v100, v102
  v_lshlrev_b32 v102, 4, v102
  v_add_u32 v102, s35, v102
  v_bfe_u32 v103, v101, 2, 1
  v_bfe_u32 v104, v101, 3, 1
  v_and_b32 v105, 3, v101
  v_lshrrev_b32 v101, 4, v101
  v_mad_u32_u24 v106, v103, 20, v105
  v_mov_b32 v100, 4
  v_mad_u32_u24 v106, v104, v100, v106
  v_mad_u32_u24 v106, v101, 8, v106
  v_add_u32 v106, 0, v106
  v_mul_u32_u24 v106, 1280, v106
  v_add_u32 v89, v106, v102
  v_mad_u32_u24 v106, v103, 20, v105
  v_mov_b32 v100, 80
  v_mad_u32_u24 v106, v104, v100, v106
  v_mad_u32_u24 v106, v101, 40, v106
  v_add_u32 v106, 16, v106
  v_mul_u32_u24 v106, 1280, v106
  v_add_u32 v94, v106, v102
  v_add_u32 v100, 128, v2
  v_mul_u32_u24 v101, 6554, v100
  v_lshrrev_b32 v101, 16, v101
  v_mul_u32_u24 v102, 10, v101
  v_sub_u32 v102, v100, v102
  v_lshlrev_b32 v102, 4, v102
  v_add_u32 v102, s35, v102
  v_bfe_u32 v103, v101, 2, 1
  v_bfe_u32 v104, v101, 3, 1
  v_and_b32 v105, 3, v101
  v_lshrrev_b32 v101, 4, v101
  v_mad_u32_u24 v106, v103, 20, v105
  v_mov_b32 v100, 4
  v_mad_u32_u24 v106, v104, v100, v106
  v_mad_u32_u24 v106, v101, 8, v106
  v_add_u32 v106, 0, v106
  v_mul_u32_u24 v106, 1280, v106
  v_add_u32 v90, v106, v102
  v_mad_u32_u24 v106, v103, 20, v105
  v_mov_b32 v100, 80
  v_mad_u32_u24 v106, v104, v100, v106
  v_mad_u32_u24 v106, v101, 40, v106
  v_add_u32 v106, 16, v106
  v_mul_u32_u24 v106, 1280, v106
  v_add_u32 v95, v106, v102
  v_add_u32 v100, 192, v2
  v_mul_u32_u24 v101, 6554, v100
  v_lshrrev_b32 v101, 16, v101
  v_mul_u32_u24 v102, 10, v101
  v_sub_u32 v102, v100, v102
  v_lshlrev_b32 v102, 4, v102
  v_add_u32 v102, s35, v102
  v_bfe_u32 v103, v101, 2, 1
  v_bfe_u32 v104, v101, 3, 1
  v_and_b32 v105, 3, v101
  v_lshrrev_b32 v101, 4, v101
  v_mad_u32_u24 v106, v103, 20, v105
  v_mov_b32 v100, 4
  v_mad_u32_u24 v106, v104, v100, v106
  v_mad_u32_u24 v106, v101, 8, v106
  v_add_u32 v106, 0, v106
  v_mul_u32_u24 v106, 1280, v106
  v_add_u32 v91, v106, v102
  v_mad_u32_u24 v106, v103, 20, v105
  v_mov_b32 v100, 80
  v_mad_u32_u24 v106, v104, v100, v106
  v_mad_u32_u24 v106, v101, 40, v106
  v_add_u32 v106, 16, v106
  v_mul_u32_u24 v106, 1280, v106
  v_add_u32 v96, v106, v102
  v_add_u32 v100, 256, v2
  v_mul_u32_u24 v101, 6554, v100
  v_lshrrev_b32 v101, 16, v101
  v_mul_u32_u24 v102, 10, v101
  v_sub_u32 v102, v100, v102
  v_lshlrev_b32 v102, 4, v102
  v_add_u32 v102, s35, v102
  v_bfe_u32 v103, v101, 2, 1
  v_bfe_u32 v104, v101, 3, 1
  v_and_b32 v105, 3, v101
  v_lshrrev_b32 v101, 4, v101
  v_mad_u32_u24 v106, v103, 20, v105
  v_mov_b32 v100, 4
  v_mad_u32_u24 v106, v104, v100, v106
  v_mad_u32_u24 v106, v101, 8, v106
  v_add_u32 v106, 0, v106
  v_mul_u32_u24 v106, 1280, v106
  v_add_u32 v92, v106, v102
  v_mad_u32_u24 v106, v103, 20, v105
  v_mov_b32 v100, 80
  v_mad_u32_u24 v106, v104, v100, v106
  v_mad_u32_u24 v106, v101, 40, v106
  v_add_u32 v106, 16, v106
  v_mul_u32_u24 v106, 1280, v106
  v_add_u32 v97, v106, v102
  v_lshlrev_b32 v8, 3, v2
  v_lshrrev_b32 v5, 1, v2
  v_mul_u32_u24 v5, 640, v5
  v_and_b32 v6, 1, v2
  v_lshl_add_u32 v5, v6, 3, v5
  v_mul_u32_u24 v9, 3456, v2
  v_mov_b32 v14, v4
  v_mov_b32 v15, v3
  v_lshlrev_b32 v11, 4, v3
  s_mul_i32 s38, s36, 27
  s_add_u32 s38, s38, s37
  s_mul_i32 s39, s36, 5
  s_add_u32 s39, s39, s37
  s_add_u32 s39, s39, 189
  s_cmp_lt_u32 s37, 27
  s_cselect_b32 s39, s38, s39
  s_cselect_b32 s14, 2211840, 0
  s_cselect_b32 s22, 2211840, 0
  s_mov_b64 s[20:21], s[66:67]
  s_mov_b64 s[16:17], s[56:57]
  s_mul_i32 s46, s34, 5376
  s_mov_b32 s43, 172544
  s_barrier
  buffer_load_dwordx2 v[4:5], v5, s[8:11], s43 offen
  s_mul_i32 s26, s38, 10240
  s_mul_i32 s27, s34, 320
  s_add_u32 s26, s26, s27
  s_add_u32 s28, s26, 5120
  buffer_load_dwordx2 v[40:41], v8, s[20:23], s26 offen offset:0
  buffer_load_dwordx2 v[42:43], v8, s[20:23], s26 offen offset:1280
  buffer_load_dwordx2 v[44:45], v8, s[20:23], s26 offen offset:2560
  buffer_load_dwordx2 v[46:47], v8, s[20:23], s26 offen offset:3840
  buffer_load_dwordx2 v[48:49], v8, s[20:23], s28 offen offset:0
  buffer_load_dwordx2 v[50:51], v8, s[20:23], s28 offen offset:1280
  buffer_load_dwordx2 v[52:53], v8, s[20:23], s28 offen offset:2560
  buffer_load_dwordx2 v[54:55], v8, s[20:23], s28 offen offset:3840
  v_mov_b32 v6, 0
  s_cmp_eq_u32 s34, 3
  s_cbranch_scc1 KF_NGW
  s_cmp_eq_u32 s34, 0
  s_cselect_b64 s[12:13], s[62:63], s[64:65]
  s_add_u32 s78, s34, 9
  s_min_u32 s78, s78, 19
  s_sub_u32 s76, s78, 10
  s_cselect_b32 s76, s78, s76
  s_mul_i32 s76, s76, 221184
  s_add_u32 s76, s76, s79
  buffer_load_dwordx4 v[152:155], v9, s[12:15], s76 offen
  s_mov_b64 s[12:13], s[64:65]
  s_add_u32 s78, s34, 12
  s_min_u32 s78, s78, 19
  s_sub_u32 s76, s78, 10
  s_cselect_b32 s76, s78, s76
  s_mul_i32 s76, s76, 221184
  s_add_u32 s76, s76, s79
  buffer_load_dwordx4 v[156:159], v9, s[12:15], s76 offen
  s_waitcnt vmcnt(10)
  s_branch KF_NGW2
KF_NGW:
  s_waitcnt vmcnt(8)
KF_NGW2:
  v_max_u32 v4, v4, v5
  s_nop 1
  v_max_u32_dpp v4, v4, v4 row_ror:8 row_mask:0xf bank_mask:0xf
  s_nop 1
  v_max_u32_dpp v4, v4, v4 row_ror:4 row_mask:0xf bank_mask:0xf
  s_nop 1
  v_max_u32_dpp v4, v4, v4 row_ror:2 row_mask:0xf bank_mask:0xf
  s_nop 1
  v_max_u32_dpp v4, v4, v4 row_ror:1 row_mask:0xf bank_mask:0xf
  v_mov_b32 v5, v4
  s_nop 1
  v_permlane16_swap_b32 v4, v5
  v_max_u32 v4, v4, v5
  v_mov_b32 v5, v4
  s_nop 1
  v_permlane32_swap_b32 v4, v5
  v_max_u32 v4, v4, v5
  s_nop 0
  v_readfirstlane_b32 s44, v4
  s_nop 0
  s_andn2_b32 s45, 0x7ff, s44
  s_mul_i32 s40, s45, 1280
  s_add_u32 s41, s40, s27
  s_lshr_b32 s42, s45, 6
  s_mul_i32 s43, s42, 640
  s_and_b32 s47, s45, 63
  s_lshl_b32 s47, s47, 3
  s_add_u32 s43, s43, s47
  s_add_u32 s43, s43, 172032
  buffer_load_dwordx4 v[16:19], v11, s[4:7], s41 offen offset:0
  buffer_load_dwordx4 v[20:23], v11, s[4:7], s41 offen offset:64
  buffer_load_dwordx4 v[24:27], v11, s[4:7], s41 offen offset:128
  buffer_load_dwordx4 v[28:31], v11, s[4:7], s41 offen offset:192
  buffer_load_dwordx4 v[32:35], v11, s[4:7], s41 offen offset:256
  buffer_load_dwordx2 v[68:69], v6, s[8:11], s43 offen
  v_bfe_u32 v12, v2, 2, 2
  v_lshl_add_u32 v12, v15, 3, v12
  v_lshlrev_b32 v12, 4, v12
  v_and_b32 v7, 1, v2
  v_lshl_add_u32 v12, v7, 3, v12
  v_bfe_u32 v7, v2, 1, 1
  v_mul_u32_u24 v7, 10240, v7
  s_mul_i32 s26, s34, 2560
  v_add3_u32 v12, v12, v7, s26
  s_lshl_b32 s26, s34, 9
  s_add_u32 s26, s26, 153216
  v_add_u32 v13, s26, v8
  s_mul_i32 s26, s34, 5376
  s_add_u32 s26, s26, 102400
  v_add_u32 v222, s26, v98
  v_and_b32 v223, 31, v2
  v_lshlrev_b32 v223, 3, v223
  v_add_u32 v223, s26, v223
  v_mov_b32 v220, 0
  s_waitcnt lgkmcnt(0)
  s_barrier
  s_add_u32 s26, s36, 2
  s_and_b32 s26, s26, 7
  s_mul_i32 s26, s26, 21504
  s_add_u32 m0, s46, 102400
  s_add_u32 s26, s26, s46
  buffer_load_dwordx4 v98, s[8:11], s26 offen offset:0 lds
  buffer_load_dwordx4 v98, s[8:11], s26 offen offset:1024 lds
  buffer_load_dwordx4 v98, s[8:11], s26 offen offset:2048 lds
  buffer_load_dwordx4 v98, s[8:11], s26 offen offset:3072 lds
  s_add_u32 m0, s46, 106496
  s_add_u32 s26, s26, 4096
  buffer_load_dwordx4 v98, s[8:11], s26 offen lds
  buffer_load_dword v99, s[8:11], s26 offen offset:1024 lds
  s_add_u32 s76, s34, 4
  s_mul_i32 s77, s76, 51200
  s_mul_i32 s76, s76, 5120
  s_add_u32 m0, s76, 0
  s_nop 0
  buffer_load_dwordx4 v88, s[16:19], s77 offen lds
  s_add_u32 m0, s76, 1024
  s_nop 0
  buffer_load_dwordx4 v89, s[16:19], s77 offen lds
  s_add_u32 m0, s76, 2048
  s_nop 0
  buffer_load_dwordx4 v90, s[16:19], s77 offen lds
  s_add_u32 m0, s76, 3072
  s_nop 0
  buffer_load_dwordx4 v91, s[16:19], s77 offen lds
  s_add_u32 m0, s76, 4096
  s_nop 0
  buffer_load_dwordx4 v92, s[16:19], s77 offen lds
  s_cmp_eq_u32 s34, 3
  s_cbranch_scc1 KF_NGW3
  s_add_u32 s78, s34, 15
  s_min_u32 s78, s78, 19
  s_sub_u32 s76, s78, 10
  s_cselect_b32 s76, s78, s76
  s_mul_i32 s76, s76, 221184
  s_add_u32 s76, s76, s79
  buffer_load_dwordx4 v[160:163], v9, s[12:15], s76 offen
  s_add_u32 s78, s34, 18
  s_min_u32 s78, s78, 19
  s_sub_u32 s76, s78, 10
  s_cselect_b32 s76, s78, s76
  s_mul_i32 s76, s76, 221184
  s_add_u32 s76, s76, s79
  buffer_load_dwordx4 v[164:167], v9, s[12:15], s76 offen
  s_lshl_b32 s26, s34, 10
  v_add_u32 v7, s26, v98
  s_min_u32 s26, s26, 1024
  v_add_u32 v6, s26, v98
  s_waitcnt vmcnt(2)
  ds_write_b128 v7, v[140:143] offset:0
  ds_write_b128 v7, v[144:147] offset:3072
  ds_write_b128 v7, v[148:151] offset:6144
  ds_write_b128 v7, v[152:155] offset:9216
  ds_write_b128 v7, v[156:159] offset:12288
  s_waitcnt vmcnt(1)
  ds_write_b128 v7, v[160:163] offset:15360
  s_waitcnt vmcnt(0)
  ds_write_b128 v6, v[164:167] offset:18432
KF_NGW3:
  v_cmp_eq_u32 vcc, 1, v14
  v_mov_b32 v7, 0x3f803f80
  s_waitcnt vmcnt(0)
  v_cndmask_b32 v16, v16, v7, vcc
  v_cndmask_b32 v17, v17, v7, vcc
  v_cndmask_b32 v18, v18, v7, vcc
  v_cndmask_b32 v19, v19, v7, vcc
  v_cndmask_b32 v20, v20, v7, vcc
  v_cndmask_b32 v21, v21, v7, vcc
  v_cndmask_b32 v22, v22, v7, vcc
  v_cndmask_b32 v23, v23, v7, vcc
  v_cndmask_b32 v24, v24, v7, vcc
  v_cndmask_b32 v25, v25, v7, vcc
  v_cndmask_b32 v26, v26, v7, vcc
  v_cndmask_b32 v27, v27, v7, vcc
  v_cndmask_b32 v28, v28, v7, vcc
  v_cndmask_b32 v29, v29, v7, vcc
  v_cndmask_b32 v30, v30, v7, vcc
  v_cndmask_b32 v31, v31, v7, vcc
  v_cndmask_b32 v32, v32, v7, vcc
  v_cndmask_b32 v33, v33, v7, vcc
  v_cndmask_b32 v34, v34, v7, vcc
  v_cndmask_b32 v35, v35, v7, vcc
  s_waitcnt lgkmcnt(0)
  s_barrier
  s_add_u32 s26, s36, 3
  s_and_b32 s26, s26, 7
  s_mul_i32 s26, s26, 21504
  s_add_u32 m0, s46, 123904
  s_add_u32 s26, s26, s46
  buffer_load_dwordx4 v98, s[8:11], s26 offen offset:0 lds
  buffer_load_dwordx4 v98, s[8:11], s26 offen offset:1024 lds
  buffer_load_dwordx4 v98, s[8:11], s26 offen offset:2048 lds
  buffer_load_dwordx4 v98, s[8:11], s26 offen offset:3072 lds
  s_add_u32 m0, s46, 128000
  s_add_u32 s26, s26, 4096
  buffer_load_dwordx4 v98, s[8:11], s26 offen lds
  buffer_load_dword v99, s[8:11], s26 offen offset:1024 lds
  s_add_u32 s76, s34, 8
  s_mul_i32 s77, s76, 51200
  s_mul_i32 s76, s76, 5120
  s_add_u32 m0, s76, 0
  s_nop 0
  buffer_load_dwordx4 v88, s[16:19], s77 offen lds
  s_add_u32 m0, s76, 1024
  s_nop 0
  buffer_load_dwordx4 v89, s[16:19], s77 offen lds
  s_add_u32 m0, s76, 2048
  s_nop 0
  buffer_load_dwordx4 v90, s[16:19], s77 offen lds
  s_add_u32 m0, s76, 3072
  s_nop 0
  buffer_load_dwordx4 v91, s[16:19], s77 offen lds
  s_add_u32 m0, s76, 4096
  s_nop 0
  buffer_load_dwordx4 v92, s[16:19], s77 offen lds
  ds_read_b64_tr_b16 v[56:57], v12 offset:0
  ds_read_b64_tr_b16 v[58:59], v12 offset:64
  s_waitcnt lgkmcnt(0)
  v_mfma_f32_16x16x32_bf16 v[64:67], v[16:19], v[56:59], 0
  ds_read_b64_tr_b16 v[60:61], v12 offset:512
  ds_read_b64_tr_b16 v[62:63], v12 offset:576
  s_waitcnt lgkmcnt(0)
  v_mfma_f32_16x16x32_bf16 v[64:67], v[20:23], v[60:63], v[64:67]
  ds_read_b64_tr_b16 v[56:57], v12 offset:1024
  ds_read_b64_tr_b16 v[58:59], v12 offset:1088
  s_waitcnt lgkmcnt(0)
  v_mfma_f32_16x16x32_bf16 v[64:67], v[24:27], v[56:59], v[64:67]
  ds_read_b64_tr_b16 v[60:61], v12 offset:1536
  ds_read_b64_tr_b16 v[62:63], v12 offset:1600
  s_waitcnt lgkmcnt(0)
  v_mfma_f32_16x16x32_bf16 v[64:67], v[28:31], v[60:63], v[64:67]
  ds_read_b64_tr_b16 v[56:57], v12 offset:2048
  ds_read_b64_tr_b16 v[58:59], v12 offset:2112
  s_waitcnt lgkmcnt(0)
  v_mfma_f32_16x16x32_bf16 v[64:67], v[32:35], v[56:59], v[64:67]
  v_lshlrev_b32 v7, 3, v14
  v_add_u32 v7, 153216, v7
  s_nop 5
  ds_write_b64 v13, v[64:65]
  s_waitcnt vmcnt(0) lgkmcnt(0)
  s_barrier
  s_add_u32 s26, s36, 4
  s_and_b32 s26, s26, 7
  s_mul_i32 s26, s26, 21504
  s_add_u32 m0, s46, 102400
  s_add_u32 s26, s26, s46
  buffer_load_dwordx4 v98, s[8:11], s26 offen offset:0 lds
  buffer_load_dwordx4 v98, s[8:11], s26 offen offset:1024 lds
  buffer_load_dwordx4 v98, s[8:11], s26 offen offset:2048 lds
  buffer_load_dwordx4 v98, s[8:11], s26 offen offset:3072 lds
  s_add_u32 m0, s46, 106496
  s_add_u32 s26, s26, 4096
  buffer_load_dwordx4 v98, s[8:11], s26 offen lds
  buffer_load_dword v99, s[8:11], s26 offen offset:1024 lds
  s_add_u32 s76, s34, 0
  s_mul_i32 s77, s76, 51200
  s_mul_i32 s76, s76, 5120
  s_add_u32 m0, s76, 0
  s_nop 0
  buffer_load_dwordx4 v88, s[16:19], s77 offen lds
  s_add_u32 m0, s76, 1024
  s_nop 0
  buffer_load_dwordx4 v89, s[16:19], s77 offen lds
  s_add_u32 m0, s76, 2048
  s_nop 0
  buffer_load_dwordx4 v90, s[16:19], s77 offen lds
  s_add_u32 m0, s76, 3072
  s_nop 0
  buffer_load_dwordx4 v91, s[16:19], s77 offen lds
  s_add_u32 m0, s76, 4096
  s_nop 0
  buffer_load_dwordx4 v92, s[16:19], s77 offen lds
  ds_read_b64 v[72:73], v7 offset:0
  ds_read_b64 v[74:75], v7 offset:512
  ds_read_b64 v[76:77], v7 offset:1024
  ds_read_b64 v[78:79], v7 offset:1536
  s_mov_b32 s26, 0x05040100
  s_mov_b32 s27, 0x07060302
  s_mul_i32 s39, s39, 2560
  s_mul_i32 s28, s34, 640
  s_add_u32 s39, s39, s28
  s_add_u32 s39, s39, 262144
  s_waitcnt lgkmcnt(0)
  v_add_f32 v72, v72, v74
  v_add_f32 v73, v73, v75
  v_add_f32 v76, v76, v78
  v_add_f32 v77, v77, v79
  v_add_f32 v72, v72, v76
  v_add_f32 v73, v73, v77
  v_fma_f32 v72, -v68, v73, v72
  v_mul_f32 v72, v72, v69
  v_cvt_pk_bf16_f32 v72, v72, v72
  v_lshlrev_b32 v72, 16, v72
  v_mul_f32 v73, 0xbfb8aa3b, v72
  v_exp_f32 v73, v73
  v_mov_b32_dpp v74, v72 row_ror:8 row_mask:0xf bank_mask:0xf
  v_add_f32 v73, 1.0, v73
  v_rcp_f32 v73, v73
  s_nop 0
  v_mul_f32 v73, v73, v72
  v_cvt_pk_bf16_f32 v73, v73, v73
  v_lshlrev_b32 v73, 16, v73
  v_mul_f32 v73, v73, v74
  v_cvt_pk_bf16_f32 v73, v73, v73
  s_nop 0
  v_readlane_b32 s48, v73, 0
  v_readlane_b32 s49, v73, 1
  v_readlane_b32 s50, v73, 2
  v_readlane_b32 s51, v73, 3
  v_readlane_b32 s52, v73, 4
  v_readlane_b32 s53, v73, 5
  v_readlane_b32 s54, v73, 6
  v_readlane_b32 s55, v73, 7
  s_pack_hh_b32_b16 s48, s48, s49
  s_pack_hh_b32_b16 s49, s50, s51
  s_pack_hh_b32_b16 s50, s52, s53
  s_pack_hh_b32_b16 s51, s54, s55
  v_perm_b32 v76, v42, v40, s26
  v_perm_b32 v77, v42, v40, s27
  v_perm_b32 v78, v43, v41, s26
  v_perm_b32 v79, v43, v41, s27
  v_dot2_f32_bf16 v84, v76, s48, 0
  v_dot2_f32_bf16 v85, v77, s48, 0
  v_dot2_f32_bf16 v86, v78, s48, 0
  v_dot2_f32_bf16 v87, v79, s48, 0
  v_perm_b32 v76, v46, v44, s26
  v_perm_b32 v77, v46, v44, s27
  v_perm_b32 v78, v47, v45, s26
  v_perm_b32 v79, v47, v45, s27
  v_dot2_f32_bf16 v84, v76, s49, v84
  v_dot2_f32_bf16 v85, v77, s49, v85
  v_dot2_f32_bf16 v86, v78, s49, v86
  v_dot2_f32_bf16 v87, v79, s49, v87
  v_perm_b32 v76, v50, v48, s26
  v_perm_b32 v77, v50, v48, s27
  v_perm_b32 v78, v51, v49, s26
  v_perm_b32 v79, v51, v49, s27
  v_dot2_f32_bf16 v84, v76, s50, v84
  v_dot2_f32_bf16 v85, v77, s50, v85
  v_dot2_f32_bf16 v86, v78, s50, v86
  v_dot2_f32_bf16 v87, v79, s50, v87
  v_perm_b32 v76, v54, v52, s26
  v_perm_b32 v77, v54, v52, s27
  v_perm_b32 v78, v55, v53, s26
  v_perm_b32 v79, v55, v53, s27
  v_dot2_f32_bf16 v84, v76, s51, v84
  v_dot2_f32_bf16 v85, v77, s51, v85
  v_dot2_f32_bf16 v86, v78, s51, v86
  v_dot2_f32_bf16 v87, v79, s51, v87
  s_mov_b32 exec_hi, 0xff
  s_waitcnt vmcnt(0)
  s_nop 0
  buffer_store_dwordx4 v[84:87], v98, s[8:11], s39 offen sc1
  s_mov_b32 exec_hi, -1
  s_getreg_b32 s28, hwreg(HW_REG_XCC_ID)
  s_and_b32 s28, s28, 15
  s_add_u32 s28, s28, 1
  v_mov_b32 v7, s28
  s_lshl_b32 s29, s32, 5
  s_add_u32 s29, s29, 192512
  s_lshl_b32 s30, s33, 2
  s_add_u32 s30, s30, s29
  s_cmp_eq_u32 s34, 0
  s_cselect_b32 s31, 0, 0x40000000
  v_mov_b32 v5, s31
  s_barrier
  s_add_u32 s26, s36, 5
  s_and_b32 s26, s26, 7
  s_mul_i32 s26, s26, 21504
  s_add_u32 m0, s46, 123904
  s_add_u32 s26, s26, s46
  buffer_load_dwordx4 v98, s[8:11], s26 offen offset:0 lds
  buffer_load_dwordx4 v98, s[8:11], s26 offen offset:1024 lds
  buffer_load_dwordx4 v98, s[8:11], s26 offen offset:2048 lds
  buffer_load_dwordx4 v98, s[8:11], s26 offen offset:3072 lds
  s_add_u32 m0, s46, 128000
  s_add_u32 s26, s26, 4096
  buffer_load_dwordx4 v98, s[8:11], s26 offen lds
  buffer_load_dword v99, s[8:11], s26 offen offset:1024 lds
  s_add_u32 s76, s34, 12
  s_mul_i32 s77, s76, 51200
  s_mul_i32 s76, s76, 5120
  s_add_u32 m0, s76, 0
  s_nop 0
  buffer_load_dwordx4 v88, s[16:19], s77 offen lds
  s_add_u32 m0, s76, 1024
  s_nop 0
  buffer_load_dwordx4 v89, s[16:19], s77 offen lds
  s_add_u32 m0, s76, 2048
  s_nop 0
  buffer_load_dwordx4 v90, s[16:19], s77 offen lds
  s_add_u32 m0, s76, 3072
  s_nop 0
  buffer_load_dwordx4 v91, s[16:19], s77 offen lds
  s_add_u32 m0, s76, 4096
  s_nop 0
  buffer_load_dwordx4 v92, s[16:19], s77 offen lds
  s_waitcnt vmcnt(0)
  s_barrier
  s_mov_b64 exec, 1
  buffer_store_dword v7, v5, s[8:11], s30 offen sc1
  s_mov_b64 exec, -1
  s_add_u32 s26, s36, 6
  s_and_b32 s26, s26, 7
  s_mul_i32 s26, s26, 21504
  s_add_u32 m0, s46, 102400
  s_add_u32 s26, s26, s46
  buffer_load_dwordx4 v98, s[8:11], s26 offen offset:0 lds
  buffer_load_dwordx4 v98, s[8:11], s26 offen offset:1024 lds
  buffer_load_dwordx4 v98, s[8:11], s26 offen offset:2048 lds
  buffer_load_dwordx4 v98, s[8:11], s26 offen offset:3072 lds
  s_add_u32 m0, s46, 106496
  s_add_u32 s26, s26, 4096
  buffer_load_dwordx4 v98, s[8:11], s26 offen lds
  buffer_load_dword v99, s[8:11], s26 offen offset:1024 lds
  s_mul_i32 s77, s34, 204800
  s_add_u32 s76, s34, 16
  s_mul_i32 s76, s76, 5120
  s_add_u32 m0, s76, 0
  s_nop 0
  buffer_load_dwordx4 v93, s[16:19], s77 offen lds
  s_add_u32 m0, s76, 1024
  s_nop 0
  buffer_load_dwordx4 v94, s[16:19], s77 offen lds
  s_add_u32 m0, s76, 2048
  s_nop 0
  buffer_load_dwordx4 v95, s[16:19], s77 offen lds
  s_add_u32 m0, s76, 3072
  s_nop 0
  buffer_load_dwordx4 v96, s[16:19], s77 offen lds
  s_add_u32 m0, s76, 4096
  s_nop 0
  buffer_load_dwordx4 v97, s[16:19], s77 offen lds
  s_cmp_eq_u32 s42, s32
  s_cselect_b32 s31, 1, 0
  s_cselect_b32 s30, 192512, s29
  s_cselect_b32 s26, 63, 1
  v_and_b32 v5, s26, v2
  v_lshlrev_b32 v5, 4, v5
  v_and_b32 v9, 7, v2
  v_lshlrev_b32 v9, 2, v9
  s_mov_b32 s47, 131072
  s_waitcnt vmcnt(0)
  s_barrier
  s_add_u32 s26, s36, 7
  s_and_b32 s26, s26, 7
  s_mul_i32 s26, s26, 21504
  s_add_u32 m0, s46, 123904
  s_add_u32 s26, s26, s46
  buffer_load_dwordx4 v98, s[8:11], s26 offen offset:0 lds
  buffer_load_dwordx4 v98, s[8:11], s26 offen offset:1024 lds
  buffer_load_dwordx4 v98, s[8:11], s26 offen offset:2048 lds
  buffer_load_dwordx4 v98, s[8:11], s26 offen offset:3072 lds
  s_add_u32 m0, s46, 128000
  s_add_u32 s26, s26, 4096
  buffer_load_dwordx4 v98, s[8:11], s26 offen lds
  buffer_load_dword v99, s[8:11], s26 offen offset:1024 lds
KF_POLL2:
  buffer_load_dwordx4 v[72:75], v5, s[8:11], s30 offen sc1
  buffer_load_dword v76, v9, s[8:11], s29 offen sc1
  s_sub_u32 s47, s47, 1
  s_cbranch_scc1 KF_GO2
  s_waitcnt vmcnt(0)
  v_min3_u32 v72, v72, v73, v74
  v_min3_u32 v72, v72, v75, v76
  v_cmp_ne_u32 vcc, 0, v72
  s_nop 0
  s_cmp_eq_u64 vcc, -1
  s_cbranch_scc0 KF_POLL2
KF_GO2:
  s_waitcnt vmcnt(0)
  v_cmp_eq_u32 vcc, s28, v76
  s_nop 0
  s_cmp_eq_u64 vcc, -1
  s_cselect_b32 s26, 1, 0
  v_mov_b32 v72, s26
  v_mov_b32 v73, s45
  v_mov_b32 v7, 151808
  ds_write_b64 v7, v[72:73] offset:32
  s_cmp_eq_u32 s31, 0
  s_cbranch_scc1 KF_NS1
  v_mul_u32_u24 v5, 3277, v2
  v_lshrrev_b32 v5, 16, v5
  v_mul_u32_u24 v7, 20, v5
  v_sub_u32 v7, v2, v7
  v_min_u32 v5, 2, v5
  s_mul_i32 s26, s34, 3
  v_add_u32 v5, s26, v5
  v_mul_u32_u24 v10, 320, v5
  v_lshl_add_u32 v10, v7, 4, v10
  v_add_u32 v10, 155264, v10
  v_mul_u32_u24 v5, 2560, v5
  v_lshl_add_u32 v5, v7, 4, v5
  s_lshl_b32 s26, s35, 1
  s_add_u32 s26, s26, 262144
  buffer_load_dwordx4 v[128:131], v5, s[8:11], s26 offen
  s_add_u32 s26, s26, 30720
  buffer_load_dwordx4 v[132:135], v5, s[8:11], s26 offen
  s_add_u32 s26, s26, 30720
  buffer_load_dwordx4 v[136:139], v5, s[8:11], s26 offen
  s_add_u32 s26, s26, 30720
  buffer_load_dwordx4 v[140:143], v5, s[8:11], s26 offen
  s_add_u32 s26, s26, 30720
  buffer_load_dwordx4 v[144:147], v5, s[8:11], s26 offen
  s_add_u32 s26, s26, 30720
  buffer_load_dwordx4 v[148:151], v5, s[8:11], s26 offen
  s_add_u32 s26, s26, 30720
  buffer_load_dwordx4 v[152:155], v5, s[8:11], s26 offen
  s_add_u32 s26, s26, 30720
  buffer_load_dwordx4 v[156:159], v5, s[8:11], s26 offen
  s_add_u32 s26, s26, 30720
  buffer_load_dwordx4 v[160:163], v5, s[8:11], s26 offen
  s_add_u32 s26, s26, 30720
  buffer_load_dwordx4 v[164:167], v5, s[8:11], s26 offen
  s_add_u32 s26, s26, 30720
  buffer_load_dwordx4 v[168:171], v5, s[8:11], s26 offen
  s_add_u32 s26, s26, 30720
  buffer_load_dwordx4 v[172:175], v5, s[8:11], s26 offen
  s_add_u32 s26, s26, 30720
  buffer_load_dwordx4 v[176:179], v5, s[8:11], s26 offen
  s_add_u32 s26, s26, 30720
  buffer_load_dwordx4 v[180:183], v5, s[8:11], s26 offen
  s_add_u32 s26, s26, 30720
  buffer_load_dwordx4 v[184:187], v5, s[8:11], s26 offen
  s_add_u32 s26, s26, 30720
  buffer_load_dwordx4 v[188:191], v5, s[8:11], s26 offen
  s_add_u32 s26, s26, 30720
  buffer_load_dwordx4 v[192:195], v5, s[8:11], s26 offen
  s_add_u32 s26, s26, 30720
  buffer_load_dwordx4 v[196:199], v5, s[8:11], s26 offen
  s_add_u32 s26, s26, 30720
  s_add_u32 s26, s40, s35
  buffer_load_dword v200, v99, s[4:7], s26 offen
  s_waitcnt vmcnt(1)
  v_pk_add_f32 v[128:129], v[128:129], v[132:133]
  v_pk_add_f32 v[130:131], v[130:131], v[134:135]
  v_pk_add_f32 v[128:129], v[128:129], v[136:137]
  v_pk_add_f32 v[130:131], v[130:131], v[138:139]
  v_pk_add_f32 v[128:129], v[128:129], v[140:141]
  v_pk_add_f32 v[130:131], v[130:131], v[142:143]
  v_pk_add_f32 v[128:129], v[128:129], v[144:145]
  v_pk_add_f32 v[130:131], v[130:131], v[146:147]
  v_pk_add_f32 v[128:129], v[128:129], v[148:149]
  v_pk_add_f32 v[130:131], v[130:131], v[150:151]
  v_pk_add_f32 v[128:129], v[128:129], v[152:153]
  v_pk_add_f32 v[130:131], v[130:131], v[154:155]
  v_pk_add_f32 v[128:129], v[128:129], v[156:157]
  v_pk_add_f32 v[130:131], v[130:131], v[158:159]
  v_pk_add_f32 v[128:129], v[128:129], v[160:161]
  v_pk_add_f32 v[130:131], v[130:131], v[162:163]
  v_pk_add_f32 v[128:129], v[128:129], v[164:165]
  v_pk_add_f32 v[130:131], v[130:131], v[166:167]
  v_pk_add_f32 v[128:129], v[128:129], v[168:169]
  v_pk_add_f32 v[130:131], v[130:131], v[170:171]
  v_pk_add_f32 v[128:129], v[128:129], v[172:173]
  v_pk_add_f32 v[130:131], v[130:131], v[174:175]
  v_pk_add_f32 v[128:129], v[128:129], v[176:177]
  v_pk_add_f32 v[130:131], v[130:131], v[178:179]
  v_pk_add_f32 v[128:129], v[128:129], v[180:181]
  v_pk_add_f32 v[130:131], v[130:131], v[182:183]
  v_pk_add_f32 v[128:129], v[128:129], v[184:185]
  v_pk_add_f32 v[130:131], v[130:131], v[186:187]
  v_pk_add_f32 v[128:129], v[128:129], v[188:189]
  v_pk_add_f32 v[130:131], v[130:131], v[190:191]
  v_pk_add_f32 v[128:129], v[128:129], v[192:193]
  v_pk_add_f32 v[130:131], v[130:131], v[194:195]
  v_pk_add_f32 v[128:129], v[128:129], v[196:197]
  v_pk_add_f32 v[130:131], v[130:131], v[198:199]
  ds_write_b128 v10, v[128:131]
KF_NS1:
  s_waitcnt vmcnt(0) lgkmcnt(0)
  s_barrier
  s_cmp_eq_u32 s34, 0
  s_cselect_b32 s31, s31, 0
  s_cmp_eq_u32 s31, 0
  s_cbranch_scc1 KF_NS2
  v_add_u32 v10, 155264, v8
  v_mov_b32 v126, 0xbfb8aa3b
  v_mov_b32 v127, 1.0
  ds_read_b64 v[128:129], v10 offset:0
  ds_read_b64 v[130:131], v10 offset:320
  ds_read_b64 v[132:133], v10 offset:640
  ds_read_b64 v[134:135], v10 offset:960
  ds_read_b64 v[136:137], v10 offset:1280
  ds_read_b64 v[138:139], v10 offset:1600
  ds_read_b64 v[140:141], v10 offset:1920
  ds_read_b64 v[142:143], v10 offset:2240
  ds_read_b64 v[144:145], v10 offset:2560
  ds_read_b64 v[146:147], v10 offset:2880
  ds_read_b64 v[148:149], v10 offset:3200
  ds_read_b64 v[150:151], v10 offset:3520
  s_lshr_b32 s26, s44, 16
  s_bitcmp1_b32 s44, 31
  s_cselect_b32 s27, 0x8000, -1
  s_xor_b32 s26, s26, s27
  s_lshl_b32 s26, s26, 16
  v_mul_f32 v204, s26, v126
  v_exp_f32 v204, v204
  s_nop 0
  v_add_f32 v204, 1.0, v204
  v_rcp_f32 v204, v204
  s_nop 0
  v_cvt_pk_bf16_f32 v204, v204, v204
  v_lshlrev_b32 v204, 16, v204
  v_and_b32 v207, 0xffff0000, v200
  v_lshlrev_b32 v206, 16, v200
  s_waitcnt lgkmcnt(0)
  v_pk_add_f32 v[128:129], v[128:129], v[130:131]
  v_pk_add_f32 v[128:129], v[128:129], v[132:133]
  v_pk_add_f32 v[128:129], v[128:129], v[134:135]
  v_pk_add_f32 v[128:129], v[128:129], v[136:137]
  v_pk_add_f32 v[128:129], v[128:129], v[138:139]
  v_pk_add_f32 v[128:129], v[128:129], v[140:141]
  v_pk_add_f32 v[128:129], v[128:129], v[142:143]
  v_pk_add_f32 v[128:129], v[128:129], v[144:145]
  v_pk_add_f32 v[128:129], v[128:129], v[146:147]
  v_pk_add_f32 v[128:129], v[128:129], v[148:149]
  v_pk_add_f32 v[128:129], v[128:129], v[150:151]
  v_cvt_pk_bf16_f32 v128, v128, v129
  v_and_b32 v129, 0xffff0000, v128
  v_lshlrev_b32 v128, 16, v128
  v_pk_mul_f32 v[128:129], v[128:129], v[204:205] op_sel_hi:[1,0]
  v_cvt_pk_bf16_f32 v128, v128, v129
  v_and_b32 v129, 0xffff0000, v128
  v_lshlrev_b32 v128, 16, v128
  v_pk_add_f32 v[210:211], v[206:207], v[68:69] op_sel_hi:[1,0] neg_lo:[0,1] neg_hi:[0,1]
  v_cvt_pk_bf16_f32 v210, v210, v211
  v_and_b32 v211, 0xffff0000, v210
  v_lshlrev_b32 v210, 16, v210
  v_pk_mul_f32 v[210:211], v[210:211], v[68:69] op_sel:[0,1] op_sel_hi:[1,1]
  v_cvt_pk_bf16_f32 v210, v210, v211
  v_and_b32 v211, 0xffff0000, v210
  v_lshlrev_b32 v210, 16, v210
  v_pk_add_f32 v[210:211], v[210:211], v[128:129]
  v_cvt_pk_bf16_f32 v210, v210, v211
  v_and_b32 v211, 0xffff0000, v210
  v_lshlrev_b32 v210, 16, v210
  v_pk_mul_f32 v[212:213], v[210:211], v[126:127] op_sel_hi:[1,0]
  v_exp_f32 v212, v212
  v_exp_f32 v213, v213
  s_nop 0
  v_pk_add_f32 v[212:213], v[212:213], v[126:127] op_sel:[0,1] op_sel_hi:[1,1]
  v_rcp_f32 v212, v212
  v_rcp_f32 v213, v213
  s_nop 0
  v_pk_mul_f32 v[210:211], v[210:211], v[212:213]
  v_cvt_pk_bf16_f32 v208, v210, v211
  v_add_u32 v10, 159104, v99
  ds_write_b32 v10, v208
KF_NS2:
  s_waitcnt vmcnt(0) lgkmcnt(0)
  s_barrier
KF_END:
  s_endpgm
CODE_END:
  s_endpgm
.section .rodata,"a"
.p2align 6
.amdhsa_kernel recurrent_scan__grouped_kv_mqa__moe_arch_mod__prompt_kernel
  .amdhsa_next_free_vgpr 256
  .amdhsa_next_free_sgpr 102
  .amdhsa_accum_offset 256
  .amdhsa_group_segment_fixed_size 0
  .amdhsa_kernarg_size 104
  .amdhsa_user_sgpr_count 2
  .amdhsa_user_sgpr_kernarg_segment_ptr 1
  .amdhsa_system_sgpr_workgroup_id_x 1
.end_amdhsa_kernel
```
